```python
import torch

def _softmax(x, axis=-1):
    return torch.softmax(x, dim=axis)
def _gelu(x):
    return torch.nn.functional.gelu(x, approximate="tanh")
def _silu(x):
    return torch.nn.functional.silu(x)
def _sigmoid(x):
    return torch.sigmoid(x)
def _layernorm(x, axis=-1, eps=1e-5):
    m = x.mean(dim=axis, keepdim=True)
    v = x.var(dim=axis, keepdim=True, unbiased=False)
    return (x - m) / torch.sqrt(v + eps)
def _scatter_add(tgt, idx, src, axis=0):
    return tgt.clone().index_add_(axis, idx, src)
def _segment_sum(src, seg, n):
    out = torch.zeros((n,) + src.shape[1:], dtype=src.dtype)
    return out.index_add_(0, seg, src)
def _pad(x, pw):
    flat = tuple(v for pair in reversed(pw) for v in pair)
    return torch.nn.functional.pad(x, flat)

kernel_name = 'standalone__sequential_behavior_din__recsys'

def setup_inputs():

    _w = (lambda a: (lambda t: t.to(torch.bfloat16) if t.is_floating_point() else t)(torch.as_tensor(a)))
    B, L, D = 4096, 200, 64
    H = D
    return {
        "target": _w((lambda *s: torch.randn(*s, dtype=torch.bfloat16) * 1.6)(B, D)),
        "hist": _w((lambda *s: torch.randn(*s, dtype=torch.bfloat16) * 1.6)(B, L, D)),
        "mask": _w((lambda lo, hi, *s: torch.randint(lo, hi, s))(0, 2, B, L).to(float)),
        "w1": _w((lambda *s: torch.randn(*s, dtype=torch.bfloat16) * 1.6)(4 * D, H) * (4 * D) ** -0.5),
        "b1": _w((lambda *s: torch.randn(*s, dtype=torch.bfloat16) * 1.6)(H) * 0.1),
        "w2": _w((lambda *s: torch.randn(*s, dtype=torch.bfloat16) * 0.05)(H, 1) * H ** -0.5),
        "b2": _w((lambda *s: torch.randn(*s, dtype=torch.bfloat16) * 0.05)(1) * 0.1),
    }

def reference(target, hist, mask, w1, b1, w2, b2):
    L = hist.shape[1]
    tgt = (lambda x, n, axis: torch.repeat_interleave(x, n, dim=axis))(target[:, None, :], L, axis=1)
    feat = torch.concatenate([hist, tgt, hist - tgt, hist * tgt], axis=-1)
    h = _sigmoid(feat @ w1 + b1)
    scores = (h @ w2 + b2)[..., 0] * mask
    return torch.einsum('bl,bld->bd', scores, hist)
```

```asm
; @launch grid=(256,1,1) block=(1024,1,1) lds=143872
.amdgcn_target "amdgcn-amd-amdhsa--gfx950"
.text
.globl standalone__sequential_behavior_din__recsys_kernel
.p2align 8
.type standalone__sequential_behavior_din__recsys_kernel,@function
standalone__sequential_behavior_din__recsys_kernel:
s_cmp_ge_u32 s2, 256
s_cbranch_scc1 L_done
s_load_dwordx16 s[4:19], s[0:1], 0
v_lshrrev_b32 v1, 6, v0
v_and_b32 v0, 63, v0
v_readfirstlane_b32 s3, v1
s_setprio 3
v_lshlrev_b32 v22, 3, v0
s_lshl_b32 s40, s2, 4
s_add_u32 s40, s40, s3
s_mul_i32 s41, s3, 5504
s_add_u32 s41, s41, 55808
s_lshl_b32 s63, s3, 11
s_mul_i32 s66, s40, 400
s_waitcnt lgkmcnt(0)
s_add_u32 s24, s8, s66
s_addc_u32 s25, s9, 0
s_mov_b32 s26, 400
s_mov_b32 s27, 0x00020000
buffer_load_dwordx2 v[78:79], v22, s[24:27], 0 offen nt
s_load_dword s62, s[16:17], 0
v_lshrrev_b32 v1, 3, v0
v_and_b32 v127, 7, v0
v_and_b32 v116, 6, v1
v_xor_b32 v126, v116, v127
v_lshlrev_b32 v126, 4, v126
v_lshl_add_u32 v32, v1, 7, v126
v_add_u32 v21, 1024, v32
v_lshlrev_b32 v112, 4, v0
s_mov_b32 s32, s10
s_mov_b32 s33, s11
s_mov_b32 s34, 32768
s_mov_b32 s35, 0x00020000
s_mov_b32 m0, s63
s_nop 0
buffer_load_dwordx4 v32, s[32:35], s63 offen  lds
s_add_u32 m0, s63, 1024
s_nop 0
buffer_load_dwordx4 v21, s[32:35], s63 offen  lds
s_cmp_ge_u32 s3, 4
s_cbranch_scc1 L_nostage
s_cmp_ge_u32 s3, 2
s_cbranch_scc1 L_stage23
s_mul_i32 s44, s2, 2048
s_add_u32 s28, s4, s44
s_addc_u32 s29, s5, 0
s_mov_b32 s30, 2048
s_mov_b32 s31, 0x00020000
s_lshl_b32 s44, s3, 10
s_add_u32 m0, s44, 32768
s_nop 0
buffer_load_dwordx4 v32, s[28:31], s44 offen nt lds
s_branch L_staged
L_stage23:
s_cmp_eq_u32 s3, 2
s_cselect_b32 s28, s12, s14
s_cselect_b32 s29, s13, s15
s_mov_b32 s44, 34944
s_cmov_b32 s44, 34816
s_mov_b32 s30, 128
s_mov_b32 s31, 0x00020000
s_mov_b32 m0, s44
s_mov_b64 exec, 0xff
buffer_load_dwordx4 v112, s[28:31], 0 offen lds
s_mov_b64 exec, -1
L_staged:
s_mov_b32 s66, 3
s_branch L_issued
L_nostage:
s_mov_b32 s66, 2
L_issued:
s_mul_i32 s44, s40, 25600
s_add_u32 s20, s6, s44
s_addc_u32 s21, s7, 0
s_mov_b32 s22, 25600
s_mov_b32 s23, 0x00020000
s_mul_i32 s44, s40, 128
s_add_u32 s36, s18, s44
s_addc_u32 s37, s19, 0
s_mov_b32 s38, 128
s_mov_b32 s39, 0x00020000
s_mov_b32 s46, 0xbfb8aa3b
s_mov_b32 s47, 0xbfb8aa3b
s_mov_b32 s68, 0x3f800000
s_mov_b32 s69, 0x08000800
v_add_u32 v1, s41, v22
v_mov_b32 v102, 0x64006400
v_mov_b32 v103, 0x64006400
ds_write_b64 v1, v[102:103] offset:4096
v_lshlrev_b32 v33, 9, v0
v_mov_b32 v113, 0xffff
s_mov_b32 s48, 0x100001
s_mov_b32 s49, 0x10000100
s_mov_b32 s50, 0x200002
s_mov_b32 s51, 0x20000200
s_mov_b32 s52, 0x400004
s_mov_b32 s53, 0x40000400
s_mov_b32 s54, 0x800008
s_mov_b32 s55, 0x80000800
v_mov_b32 v127, 0xffff0000
v_cndmask_b32 v110, 0, v113, s[48:49]
v_cndmask_b32 v111, 0, v113, s[52:53]
v_cndmask_b32 v110, v110, v127, s[50:51]
v_cndmask_b32 v111, v111, v127, s[54:55]
v_lshrrev_b32 v31, 4, v0
v_and_b32 v74, 0x3f803f80, v110
v_and_b32 v75, 0x3f803f80, v111
v_and_b32 v76, 0x3f803f80, v110
v_and_b32 v77, 0x3f803f80, v111
v_bfe_u32 v1, v0, 2, 2
v_lshl_add_u32 v127, v31, 3, v1
v_and_b32 v1, 2, v1
v_bfe_u32 v12, v0, 1, 1
v_or_b32 v1, v1, v12
v_and_b32 v13, 1, v0
v_lshlrev_b32 v13, 3, v13
v_lshl_add_u32 v1, v1, 4, v13
v_lshl_add_u32 v116, v127, 7, v1
s_and_b32 s44, s3, 7
s_lshl_b32 s44, s44, 5
s_and_b32 s45, s44, 0x60
s_and_b32 s44, s44, 0x80
s_lshr_b32 s44, s44, 1
s_xor_b32 s45, s45, s44
v_xor_b32 v25, s45, v116
s_lshr_b32 s45, s3, 3
s_lshl_b32 s45, s45, 12
s_lshl_b32 s44, s44, 3
s_add_u32 s44, s44, s45
v_add_u32 v25, s44, v25
s_lshl_b32 s44, s3, 10
v_add_u32 v28, s44, v112
v_and_b32 v14, 15, v0
v_and_b32 v127, 6, v14
v_xor_b32 v127, v127, v31
v_lshlrev_b32 v127, 4, v127
v_lshl_add_u32 v19, v14, 7, v127
v_lshlrev_b32 v115, 3, v31
v_lshrrev_b32 v1, 3, v0
v_lshlrev_b32 v1, 2, v1
v_add_u32 v124, s41, v1
v_add_u32 v89, 128, v33
v_add_u32 v90, 256, v33
v_add_u32 v91, 384, v33
s_add_u32 s45, s41, 4096
s_cmp_eq_u32 s66, 3
s_cbranch_scc1 L_wait3
s_waitcnt vmcnt(2)
s_branch L_mask
L_wait3:
s_waitcnt vmcnt(3)
L_mask:
v_lshlrev_b32 v80, 16, v78
v_and_b32 v81, 0xffff0000, v78
v_lshlrev_b32 v82, 16, v79
v_and_b32 v83, 0xffff0000, v79
v_cmp_ne_u32 s[48:49], 0, v80
v_cmp_ne_u32 s[50:51], 0, v81
v_cmp_ne_u32 s[52:53], 0, v82
v_cmp_ne_u32 s[54:55], 0, v83
s_nop 0
v_mbcnt_lo_u32_b32 v84, s48, 0
v_mbcnt_hi_u32_b32 v84, s49, v84
v_mbcnt_lo_u32_b32 v84, s50, v84
v_mbcnt_hi_u32_b32 v84, s51, v84
v_mbcnt_lo_u32_b32 v84, s52, v84
v_mbcnt_hi_u32_b32 v84, s53, v84
v_mbcnt_lo_u32_b32 v84, s54, v84
v_mbcnt_hi_u32_b32 v84, s55, v84
s_bcnt1_i32_b64 s42, s[48:49]
s_bcnt1_i32_b64 s44, s[50:51]
s_add_u32 s42, s42, s44
s_bcnt1_i32_b64 s44, s[52:53]
s_add_u32 s42, s42, s44
s_bcnt1_i32_b64 s44, s[54:55]
s_add_u32 s42, s42, s44
v_addc_co_u32 v85, s[64:65], v84, 0, s[48:49]
v_addc_co_u32 v86, s[64:65], v85, 0, s[50:51]
v_addc_co_u32 v87, s[64:65], v86, 0, s[52:53]
v_lshl_add_u32 v1, v84, 1, s45
s_mov_b64 exec, s[48:49]
ds_write_b16 v1, v33
s_mov_b64 exec, -1
v_lshl_add_u32 v1, v85, 1, s45
s_mov_b64 exec, s[50:51]
ds_write_b16 v1, v89
s_mov_b64 exec, -1
v_lshl_add_u32 v1, v86, 1, s45
s_mov_b64 exec, s[52:53]
ds_write_b16 v1, v90
s_mov_b64 exec, -1
v_lshl_add_u32 v1, v87, 1, s45
s_mov_b64 exec, s[54:55]
ds_write_b16 v1, v91
s_mov_b64 exec, -1
ds_read_b32 v116, v124 offset:4096
ds_read_b32 v102, v124 offset:4128
s_add_u32 s43, s42, 15
s_lshr_b32 s43, s43, 4
s_waitcnt lgkmcnt(0)
v_add_u32_sdwa v117, v126, v116 dst_sel:DWORD dst_unused:UNUSED_PAD src0_sel:DWORD src1_sel:WORD_1
v_add_u32_sdwa v116, v126, v116 dst_sel:DWORD dst_unused:UNUSED_PAD src0_sel:DWORD src1_sel:WORD_0
s_add_u32 m0, s41, 0
s_nop 0
buffer_load_dwordx4 v116, s[20:23], 0 offen nt lds
s_add_u32 m0, s41, 1024
s_nop 0
buffer_load_dwordx4 v117, s[20:23], 0 offen nt lds
v_cmp_ne_u32 s[4:5], s68, v80
v_cmp_ne_u32 s[6:7], s68, v81
v_cmp_ne_u32 s[8:9], s68, v82
v_cmp_ne_u32 s[10:11], s68, v83
s_nop 0
s_and_b64 s[4:5], s[4:5], s[48:49]
s_and_b64 s[6:7], s[6:7], s[50:51]
s_and_b64 s[8:9], s[8:9], s[52:53]
s_and_b64 s[10:11], s[10:11], s[54:55]
s_or_b64 s[4:5], s[4:5], s[6:7]
s_or_b64 s[8:9], s[8:9], s[10:11]
s_or_b64 s[4:5], s[4:5], s[8:9]
s_cselect_b32 s67, 1, 0
s_cbranch_scc0 L_masks_done
v_mov_b32 v106, 0
v_mov_b32 v107, 0
v_mov_b32 v108, 0
v_mov_b32 v109, 0
v_add_u32 v127, s41, v112
s_mov_b32 exec_hi, 0xfffff
ds_write_b128 v127, v[106:109] offset:4608
s_mov_b32 exec_hi, -1
v_and_b32 v1, 15, v84
v_sub_u32 v127, v84, v1
v_lshrrev_b32 v88, 1, v1
v_and_b32 v1, 1, v1
v_lshl_add_u32 v1, v1, 3, v88
v_add_u32 v127, v127, v1
v_lshl_add_u32 v127, v127, 2, s41
s_mov_b64 exec, s[48:49]
ds_write_b32 v127, v80 offset:4608
s_mov_b64 exec, -1
v_and_b32 v1, 15, v85
v_sub_u32 v127, v85, v1
v_lshrrev_b32 v89, 1, v1
v_and_b32 v1, 1, v1
v_lshl_add_u32 v1, v1, 3, v89
v_add_u32 v127, v127, v1
v_lshl_add_u32 v127, v127, 2, s41
s_mov_b64 exec, s[50:51]
ds_write_b32 v127, v81 offset:4608
s_mov_b64 exec, -1
v_and_b32 v1, 15, v86
v_sub_u32 v127, v86, v1
v_lshrrev_b32 v90, 1, v1
v_and_b32 v1, 1, v1
v_lshl_add_u32 v1, v1, 3, v90
v_add_u32 v127, v127, v1
v_lshl_add_u32 v127, v127, 2, s41
s_mov_b64 exec, s[52:53]
ds_write_b32 v127, v82 offset:4608
s_mov_b64 exec, -1
v_and_b32 v1, 15, v87
v_sub_u32 v127, v87, v1
v_lshrrev_b32 v91, 1, v1
v_and_b32 v1, 1, v1
v_lshl_add_u32 v1, v1, 3, v91
v_add_u32 v127, v127, v1
v_lshl_add_u32 v127, v127, 2, s41
s_mov_b64 exec, s[54:55]
ds_write_b32 v127, v83 offset:4608
s_mov_b64 exec, -1
s_waitcnt lgkmcnt(0)
L_masks_done:
s_waitcnt vmcnt(2)
s_barrier
ds_read_b64_tr_b16 v[78:79], v25 offset:0
ds_read_b64_tr_b16 v[80:81], v25 offset:16384
ds_read_b64_tr_b16 v[82:83], v25 offset:24576
s_cmp_ge_u32 s3, 4
s_cbranch_scc1 L_nobias
s_lshl_b32 s44, s3, 5
v_add_u32 v18, s44, v115
v_xor_b32 v26, 64, v19
v_xor_b32 v24, 64, v25
ds_read_b64 v[58:59], v18 offset:34816
ds_read_b128 v[2:5], v19 offset:32768
ds_read_b128 v[6:9], v26 offset:32768
ds_read_b64_tr_b16 v[34:35], v25 offset:8192
ds_read_b64_tr_b16 v[42:43], v25 offset:16384
ds_read_b64_tr_b16 v[36:37], v24 offset:8704
ds_read_b64_tr_b16 v[44:45], v24 offset:16896
ds_read_b64_tr_b16 v[38:39], v25 offset:12288
ds_read_b64_tr_b16 v[46:47], v25 offset:20480
ds_read_b64_tr_b16 v[40:41], v24 offset:12800
ds_read_b64_tr_b16 v[48:49], v24 offset:20992
v_lshlrev_b32 v27, 8, v14
v_lshl_add_u32 v27, v31, 4, v27
s_lshl_b32 s44, s3, 6
v_add_u32 v27, s44, v27
s_waitcnt lgkmcnt(10)
v_mfma_f32_16x16x16_bf16 v[90:93], v[76:77], v[82:83], 0
v_mfma_f32_16x16x32_bf16 v[86:89], v[74:77], v[78:81], 0
v_lshlrev_b32 v50, 16, v58
v_and_b32 v51, 0xffff0000, v58
v_lshlrev_b32 v52, 16, v59
v_and_b32 v53, 0xffff0000, v59
s_waitcnt lgkmcnt(0)
v_mfma_f32_16x16x32_bf16 v[54:57], v[42:45], v[2:5], 0
v_mfma_f32_16x16x32_bf16 v[50:53], v[34:37], v[2:5], v[50:53]
v_mfma_f32_16x16x32_bf16 v[54:57], v[46:49], v[6:9], v[54:57]
v_mfma_f32_16x16x32_bf16 v[50:53], v[38:41], v[6:9], v[50:53]
v_mul_f32 v90, s46, v90
v_mul_f32 v91, s46, v91
v_mul_f32 v92, s46, v92
v_mul_f32 v93, s46, v93
v_mul_f32 v86, s46, v86
v_mul_f32 v87, s46, v87
v_mul_f32 v88, s46, v88
v_mul_f32 v89, s46, v89
v_cvt_pk_bf16_f32 v94, v90, v91
v_cvt_pk_bf16_f32 v95, v92, v93
v_cvt_pk_bf16_f32 v96, v86, v87
v_cvt_pk_bf16_f32 v97, v88, v89
ds_write_b128 v28, v[94:97] offset:39424
v_bfe_u32 v121, v0, 2, 2
v_lshl_add_u32 v121, v31, 2, v121
v_and_b32 v122, 6, v121
v_or_b32 v122, v122, v12
v_lshl_add_u32 v122, v122, 4, v13
v_lshl_add_u32 v122, v121, 7, v122
v_add_u32 v120, s41, v122
v_xor_b32 v121, 32, v120
v_xor_b32 v122, 64, v120
v_xor_b32 v123, 96, v120
v_sub_f32 v50, v50, v54
v_sub_f32 v51, v51, v55
v_sub_f32 v52, v52, v56
v_sub_f32 v53, v53, v57
v_mov_b32 v58, 0xc1500000
v_fma_f32 v50, v50, s46, v58
v_fma_f32 v51, v51, s46, v58
v_fma_f32 v52, v52, s46, v58
v_fma_f32 v53, v53, s46, v58
ds_write_b128 v27, v[50:53] offset:35328
s_branch L_p3_done
L_nobias:
s_cmp_eq_u32 s3, 4
s_cbranch_scc1 L_w2
s_waitcnt lgkmcnt(0)
v_mfma_f32_16x16x16_bf16 v[90:93], v[76:77], v[82:83], 0
v_mfma_f32_16x16x32_bf16 v[86:89], v[74:77], v[78:81], 0
v_bfe_u32 v121, v0, 2, 2
v_lshl_add_u32 v121, v31, 2, v121
v_and_b32 v122, 6, v121
v_or_b32 v122, v122, v12
v_lshl_add_u32 v122, v122, 4, v13
v_lshl_add_u32 v122, v121, 7, v122
v_add_u32 v120, s41, v122
v_xor_b32 v121, 32, v120
v_xor_b32 v122, 64, v120
v_xor_b32 v123, 96, v120
v_mul_f32 v90, s46, v90
v_mul_f32 v91, s46, v91
v_mul_f32 v92, s46, v92
v_mul_f32 v93, s46, v93
v_mul_f32 v86, s46, v86
v_mul_f32 v87, s46, v87
v_mul_f32 v88, s46, v88
v_mul_f32 v89, s46, v89
v_cvt_pk_bf16_f32 v94, v90, v91
v_cvt_pk_bf16_f32 v95, v92, v93
v_cvt_pk_bf16_f32 v96, v86, v87
v_cvt_pk_bf16_f32 v97, v88, v89
ds_write_b128 v28, v[94:97] offset:39424
s_branch L_p3_done
L_w2:
v_lshlrev_b32 v1, 1, v0
ds_read_u16 v127, v1 offset:34944
s_waitcnt lgkmcnt(0)
v_mfma_f32_16x16x16_bf16 v[90:93], v[76:77], v[82:83], 0
v_mfma_f32_16x16x32_bf16 v[86:89], v[74:77], v[78:81], 0
v_bfe_u32 v116, v127, 7, 8
s_nop 1
v_max_u32_dpp v116, v116, v116 row_shr:1 row_mask:0xf bank_mask:0xf bound_ctrl:0
s_nop 1
v_max_u32_dpp v116, v116, v116 row_shr:2 row_mask:0xf bank_mask:0xf bound_ctrl:0
s_nop 1
v_max_u32_dpp v116, v116, v116 row_shr:4 row_mask:0xf bank_mask:0xf bound_ctrl:0
s_nop 1
v_max_u32_dpp v116, v116, v116 row_shr:8 row_mask:0xf bank_mask:0xf bound_ctrl:0
s_nop 1
v_max_u32_dpp v116, v116, v116 row_bcast:15 row_mask:0xa bank_mask:0xf
s_nop 1
v_max_u32_dpp v116, v116, v116 row_bcast:31 row_mask:0xc bank_mask:0xf
v_mul_f32 v90, s46, v90
v_mul_f32 v91, s46, v91
v_mul_f32 v92, s46, v92
v_mul_f32 v93, s46, v93
v_mul_f32 v86, s46, v86
v_mul_f32 v87, s46, v87
v_mul_f32 v88, s46, v88
v_mul_f32 v89, s46, v89
v_cvt_pk_bf16_f32 v94, v90, v91
v_cvt_pk_bf16_f32 v95, v92, v93
v_cvt_pk_bf16_f32 v96, v86, v87
v_cvt_pk_bf16_f32 v97, v88, v89
ds_write_b128 v28, v[94:97] offset:39424
v_bfe_u32 v121, v0, 2, 2
v_lshl_add_u32 v121, v31, 2, v121
v_and_b32 v122, 6, v121
v_or_b32 v122, v122, v12
v_lshl_add_u32 v122, v122, 4, v13
v_lshl_add_u32 v122, v121, 7, v122
v_add_u32 v120, s41, v122
v_xor_b32 v121, 32, v120
v_xor_b32 v122, 64, v120
v_xor_b32 v123, 96, v120
v_readlane_b32 s66, v116, 63
v_lshlrev_b32 v127, 16, v127
s_nop 1
s_bfe_u32 s44, s62, 0x80007
s_max_u32 s44, s44, 80
s_sub_u32 s44, s44, 80
s_max_u32 s66, s66, s44
s_max_u32 s66, s66, 14
s_min_u32 s66, s66, 253
s_sub_u32 s44, 254, s66
s_lshl_b32 s44, s44, 23
s_sub_u32 s66, s66, 13
s_lshl_b32 s66, s66, 23
v_mul_f32 v127, s44, v127
s_add_u32 s44, s44, 0x6800000
v_mov_b32 v116, s44
v_cvt_f16_f32 v127, v127
v_mov_b32 v117, s66
ds_write_b16 v1, v127 offset:35072
v_mov_b32 v1, 0
ds_write_b64 v1, v[116:117] offset:35200
L_p3_done:
s_waitcnt lgkmcnt(0)
s_barrier
v_add_u32_sdwa v103, v126, v102 dst_sel:DWORD dst_unused:UNUSED_PAD src0_sel:DWORD src1_sel:WORD_1
v_add_u32_sdwa v102, v126, v102 dst_sel:DWORD dst_unused:UNUSED_PAD src0_sel:DWORD src1_sel:WORD_0
s_add_u32 m0, s41, 2048
s_nop 0
buffer_load_dwordx4 v102, s[20:23], 0 offen nt lds
s_add_u32 m0, s41, 3072
s_nop 0
buffer_load_dwordx4 v103, s[20:23], 0 offen nt lds
s_cmp_lt_u32 s3, 4
s_cbranch_scc1 L_p4prio
s_setprio 2
s_cmp_lt_u32 s3, 8
s_cbranch_scc1 L_p4prio
s_setprio 1
s_cmp_lt_u32 s3, 12
s_cbranch_scc1 L_p4prio
s_setprio 0
L_p4prio:
s_and_b32 s44, s3, 6
v_xor_b32 v29, s44, v31
s_lshl_b32 s44, s3, 7
s_add_u32 s44, s44, 32768
v_lshl_add_u32 v29, v29, 4, s44
v_xor_b32 v30, 64, v29
ds_read_b128 v[94:97], v29
ds_read_b128 v[98:101], v30
ds_read_b128 v[78:81], v112 offset:39424
ds_read_b128 v[82:85], v112 offset:40448
ds_read_b128 v[86:89], v112 offset:41472
ds_read_b128 v[90:93], v112 offset:42496
ds_read_b128 v[50:53], v112 offset:43520
ds_read_b128 v[54:57], v112 offset:44544
ds_read_b128 v[58:61], v112 offset:45568
ds_read_b128 v[62:65], v112 offset:46592
v_add_u32 v118, s41, v19
v_xor_b32 v119, 64, v118
v_lshlrev_b32 v125, 4, v31
s_lshl_b32 s44, s3, 8
v_add_u32 v114, s44, v125
v_add_u32 v125, s41, v125
s_waitcnt lgkmcnt(8)
v_and_b32 v74, v94, v110
v_and_b32 v75, v95, v111
s_nop 0
s_waitcnt lgkmcnt(4)
v_mfma_f32_16x16x32_bf16 v[34:37], v[74:77], v[78:81], 0
v_mfma_f32_16x16x32_bf16 v[38:41], v[74:77], v[82:85], 0
v_mfma_f32_16x16x32_bf16 v[42:45], v[74:77], v[86:89], 0
v_mfma_f32_16x16x32_bf16 v[46:49], v[74:77], v[90:93], 0
ds_read_b128 v[78:81], v112 offset:47616
ds_read_b128 v[82:85], v112 offset:48640
ds_read_b128 v[86:89], v112 offset:49664
ds_read_b128 v[90:93], v112 offset:50688
v_and_b32 v74, v96, v110
v_and_b32 v75, v97, v111
v_cvt_pk_bf16_f32 v2, v34, v35
v_cvt_pk_bf16_f32 v3, v36, v37
v_cvt_pk_bf16_f32 v10, v38, v39
v_cvt_pk_bf16_f32 v11, v40, v41
v_cvt_pk_bf16_f32 v18, v42, v43
v_cvt_pk_bf16_f32 v19, v44, v45
v_cvt_pk_bf16_f32 v26, v46, v47
v_cvt_pk_bf16_f32 v27, v48, v49
s_waitcnt lgkmcnt(4)
v_mfma_f32_16x16x32_bf16 v[34:37], v[74:77], v[50:53], 0
v_mfma_f32_16x16x32_bf16 v[38:41], v[74:77], v[54:57], 0
v_mfma_f32_16x16x32_bf16 v[42:45], v[74:77], v[58:61], 0
v_mfma_f32_16x16x32_bf16 v[46:49], v[74:77], v[62:65], 0
ds_read_b128 v[50:53], v112 offset:51712
ds_read_b128 v[54:57], v112 offset:52736
ds_read_b128 v[58:61], v112 offset:53760
ds_read_b128 v[62:65], v112 offset:54784
v_and_b32 v74, v98, v110
v_and_b32 v75, v99, v111
v_cvt_pk_bf16_f32 v4, v34, v35
v_cvt_pk_bf16_f32 v5, v36, v37
v_cvt_pk_bf16_f32 v12, v38, v39
v_cvt_pk_bf16_f32 v13, v40, v41
v_cvt_pk_bf16_f32 v20, v42, v43
v_cvt_pk_bf16_f32 v21, v44, v45
v_cvt_pk_bf16_f32 v28, v46, v47
v_cvt_pk_bf16_f32 v29, v48, v49
s_waitcnt lgkmcnt(4)
v_mfma_f32_16x16x32_bf16 v[34:37], v[74:77], v[78:81], 0
v_mfma_f32_16x16x32_bf16 v[38:41], v[74:77], v[82:85], 0
v_mfma_f32_16x16x32_bf16 v[42:45], v[74:77], v[86:89], 0
v_mfma_f32_16x16x32_bf16 v[46:49], v[74:77], v[90:93], 0
ds_read_b64 v[66:67], v115 offset:35072
ds_read_b64 v[68:69], v115 offset:35104
ds_read_b64 v[70:71], v115 offset:35136
ds_read_b64 v[72:73], v115 offset:35168
v_and_b32 v74, v100, v110
v_and_b32 v75, v101, v111
v_cvt_pk_bf16_f32 v6, v34, v35
v_cvt_pk_bf16_f32 v7, v36, v37
v_cvt_pk_bf16_f32 v14, v38, v39
v_cvt_pk_bf16_f32 v15, v40, v41
v_cvt_pk_bf16_f32 v22, v42, v43
v_cvt_pk_bf16_f32 v23, v44, v45
v_cvt_pk_bf16_f32 v30, v46, v47
v_cvt_pk_bf16_f32 v31, v48, v49
s_waitcnt lgkmcnt(4)
v_mfma_f32_16x16x32_bf16 v[34:37], v[74:77], v[50:53], 0
v_mfma_f32_16x16x32_bf16 v[38:41], v[74:77], v[54:57], 0
v_mfma_f32_16x16x32_bf16 v[42:45], v[74:77], v[58:61], 0
v_mfma_f32_16x16x32_bf16 v[46:49], v[74:77], v[62:65], 0
s_nop 3
s_lshl_b32 s62, s62, 16
s_nop 0
v_cvt_pk_bf16_f32 v8, v34, v35
v_cvt_pk_bf16_f32 v9, v36, v37
v_cvt_pk_bf16_f32 v16, v38, v39
v_cvt_pk_bf16_f32 v17, v40, v41
v_cvt_pk_bf16_f32 v24, v42, v43
v_cvt_pk_bf16_f32 v25, v44, v45
v_cvt_pk_bf16_f32 v32, v46, v47
v_cvt_pk_bf16_f32 v33, v48, v49
ds_read_b128 v[34:37], v114 offset:35328
ds_read_b128 v[38:41], v114 offset:35392
ds_read_b128 v[42:45], v114 offset:35456
ds_read_b128 v[46:49], v114 offset:35520
v_mov_b32 v1, 0
ds_read_b64 v[116:117], v1 offset:35200
s_cmp_eq_u32 s43, 0
s_cbranch_scc1 L_empty
s_waitcnt lgkmcnt(0)
v_readfirstlane_b32 s66, v117
v_mul_f32 v74, s62, v116
v_mul_f32 v75, s62, v116
v_mul_f32 v76, s62, v116
v_mul_f32 v77, s62, v116
s_waitcnt vmcnt(2)
ds_read_b128 v[94:97], v118 offset:0
ds_read_b128 v[98:101], v119 offset:0
s_cmp_eq_u32 s67, 0
s_waitcnt lgkmcnt(0)
v_mfma_f32_16x16x32_bf16 v[78:81], v[2:5], v[94:97], v[34:37]
v_mfma_f32_16x16x32_bf16 v[78:81], v[6:9], v[98:101], v[78:81]
v_mfma_f32_16x16x32_bf16 v[82:85], v[10:13], v[94:97], v[38:41]
v_mfma_f32_16x16x32_bf16 v[82:85], v[14:17], v[98:101], v[82:85]
v_mfma_f32_16x16x32_bf16 v[86:89], v[18:21], v[94:97], v[42:45]
v_mfma_f32_16x16x32_bf16 v[86:89], v[22:25], v[98:101], v[86:89]
v_mfma_f32_16x16x32_bf16 v[90:93], v[26:29], v[94:97], v[46:49]
v_mfma_f32_16x16x32_bf16 v[90:93], v[30:33], v[98:101], v[90:93]
s_cbranch_scc0 L_general
s_setprio 2
s_nop 1
v_exp_f32 v78, v78
v_exp_f32 v79, v79
v_exp_f32 v80, v80
v_exp_f32 v81, v81
v_exp_f32 v82, v82
v_exp_f32 v83, v83
v_exp_f32 v84, v84
v_exp_f32 v85, v85
v_exp_f32 v86, v86
v_exp_f32 v87, v87
v_exp_f32 v88, v88
v_exp_f32 v89, v89
v_exp_f32 v90, v90
v_exp_f32 v91, v91
v_exp_f32 v92, v92
v_exp_f32 v93, v93
ds_read_b64_tr_b16 v[102:103], v120 offset:0
ds_read_b64_tr_b16 v[104:105], v121 offset:0
ds_read_b64_tr_b16 v[106:107], v122 offset:0
ds_read_b64_tr_b16 v[108:109], v123 offset:0
ds_read_b32 v116, v124 offset:4160
v_cvt_pk_f16_f32 v78, v78, v79
v_cvt_pk_f16_f32 v79, v80, v81
v_cvt_pk_f16_f32 v80, v82, v83
v_cvt_pk_f16_f32 v81, v84, v85
v_cvt_pk_f16_f32 v82, v86, v87
v_cvt_pk_f16_f32 v83, v88, v89
v_cvt_pk_f16_f32 v84, v90, v91
v_cvt_pk_f16_f32 v85, v92, v93
v_pk_add_f16 v78, v78, s69
v_pk_add_f16 v79, v79, s69
v_pk_add_f16 v80, v80, s69
v_pk_add_f16 v81, v81, s69
v_pk_add_f16 v82, v82, s69
v_pk_add_f16 v83, v83, s69
v_pk_add_f16 v84, v84, s69
v_pk_add_f16 v85, v85, s69
v_rcp_f16_sdwa v78, v78 dst_sel:WORD_0 dst_unused:UNUSED_PRESERVE src0_sel:WORD_0
v_rcp_f16_sdwa v79, v79 dst_sel:WORD_0 dst_unused:UNUSED_PRESERVE src0_sel:WORD_0
v_rcp_f16_sdwa v80, v80 dst_sel:WORD_0 dst_unused:UNUSED_PRESERVE src0_sel:WORD_0
v_rcp_f16_sdwa v81, v81 dst_sel:WORD_0 dst_unused:UNUSED_PRESERVE src0_sel:WORD_0
v_rcp_f16_sdwa v82, v82 dst_sel:WORD_0 dst_unused:UNUSED_PRESERVE src0_sel:WORD_0
v_rcp_f16_sdwa v83, v83 dst_sel:WORD_0 dst_unused:UNUSED_PRESERVE src0_sel:WORD_0
v_rcp_f16_sdwa v84, v84 dst_sel:WORD_0 dst_unused:UNUSED_PRESERVE src0_sel:WORD_0
v_rcp_f16_sdwa v85, v85 dst_sel:WORD_0 dst_unused:UNUSED_PRESERVE src0_sel:WORD_0
s_waitcnt lgkmcnt(0)
v_add_u32_sdwa v117, v126, v116 dst_sel:DWORD dst_unused:UNUSED_PAD src0_sel:DWORD src1_sel:WORD_1
v_add_u32_sdwa v116, v126, v116 dst_sel:DWORD dst_unused:UNUSED_PAD src0_sel:DWORD src1_sel:WORD_0
s_add_u32 m0, s41, 0
s_nop 0
buffer_load_dwordx4 v116, s[20:23], 0 offen nt lds
s_add_u32 m0, s41, 1024
s_nop 0
buffer_load_dwordx4 v117, s[20:23], 0 offen nt lds
s_waitcnt vmcnt(2)
ds_read_b128 v[94:97], v118 offset:2048
ds_read_b128 v[98:101], v119 offset:2048
v_rcp_f16_sdwa v78, v78 dst_sel:WORD_1 dst_unused:UNUSED_PRESERVE src0_sel:WORD_1
v_rcp_f16_sdwa v79, v79 dst_sel:WORD_1 dst_unused:UNUSED_PRESERVE src0_sel:WORD_1
v_rcp_f16_sdwa v80, v80 dst_sel:WORD_1 dst_unused:UNUSED_PRESERVE src0_sel:WORD_1
v_rcp_f16_sdwa v81, v81 dst_sel:WORD_1 dst_unused:UNUSED_PRESERVE src0_sel:WORD_1
v_rcp_f16_sdwa v82, v82 dst_sel:WORD_1 dst_unused:UNUSED_PRESERVE src0_sel:WORD_1
v_rcp_f16_sdwa v83, v83 dst_sel:WORD_1 dst_unused:UNUSED_PRESERVE src0_sel:WORD_1
v_rcp_f16_sdwa v84, v84 dst_sel:WORD_1 dst_unused:UNUSED_PRESERVE src0_sel:WORD_1
v_rcp_f16_sdwa v85, v85 dst_sel:WORD_1 dst_unused:UNUSED_PRESERVE src0_sel:WORD_1
s_cmp_le_u32 s43, 1
s_nop 0
v_mfma_f32_16x16x32_f16 v[114:117], v[78:81], v[66:69], v[74:77]
v_mfma_f32_16x16x32_f16 v[114:117], v[82:85], v[70:73], v[114:117]
s_cbranch_scc1 L_drain0
s_waitcnt lgkmcnt(0)
v_mfma_f32_16x16x32_bf16 v[78:81], v[2:5], v[94:97], v[34:37]
v_mfma_f32_16x16x32_bf16 v[78:81], v[6:9], v[98:101], v[78:81]
v_mfma_f32_16x16x32_bf16 v[82:85], v[10:13], v[94:97], v[38:41]
v_mfma_f32_16x16x32_bf16 v[82:85], v[14:17], v[98:101], v[82:85]
v_mfma_f32_16x16x32_bf16 v[86:89], v[18:21], v[94:97], v[42:45]
v_mfma_f32_16x16x32_bf16 v[86:89], v[22:25], v[98:101], v[86:89]
v_mfma_f32_16x16x32_bf16 v[90:93], v[26:29], v[94:97], v[46:49]
v_mfma_f32_16x16x32_bf16 v[90:93], v[30:33], v[98:101], v[90:93]
s_setprio 1
v_cvt_pk_bf16_f32 v114, v114, v115
v_cvt_pk_bf16_f32 v115, v116, v117
v_exp_f32 v78, v78
v_exp_f32 v79, v79
v_exp_f32 v80, v80
v_exp_f32 v81, v81
v_mfma_f32_4x4x4_16b_bf16 v[50:53], v[114:115], v[102:103], 0
v_exp_f32 v82, v82
v_exp_f32 v83, v83
v_exp_f32 v84, v84
v_exp_f32 v85, v85
v_mfma_f32_4x4x4_16b_bf16 v[54:57], v[114:115], v[104:105], 0
v_exp_f32 v86, v86
v_exp_f32 v87, v87
v_exp_f32 v88, v88
v_exp_f32 v89, v89
v_mfma_f32_4x4x4_16b_bf16 v[58:61], v[114:115], v[106:107], 0
v_exp_f32 v90, v90
v_exp_f32 v91, v91
v_exp_f32 v92, v92
v_exp_f32 v93, v93
v_mfma_f32_4x4x4_16b_bf16 v[62:65], v[114:115], v[108:109], 0
ds_read_b64_tr_b16 v[102:103], v120 offset:2048
ds_read_b64_tr_b16 v[104:105], v121 offset:2048
ds_read_b64_tr_b16 v[106:107], v122 offset:2048
ds_read_b64_tr_b16 v[108:109], v123 offset:2048
ds_read_b32 v116, v124 offset:4192
v_cvt_pk_f16_f32 v78, v78, v79
v_cvt_pk_f16_f32 v79, v80, v81
v_cvt_pk_f16_f32 v80, v82, v83
v_cvt_pk_f16_f32 v81, v84, v85
v_cvt_pk_f16_f32 v82, v86, v87
v_cvt_pk_f16_f32 v83, v88, v89
v_cvt_pk_f16_f32 v84, v90, v91
v_cvt_pk_f16_f32 v85, v92, v93
v_pk_add_f16 v78, v78, s69
v_pk_add_f16 v79, v79, s69
v_pk_add_f16 v80, v80, s69
v_pk_add_f16 v81, v81, s69
v_pk_add_f16 v82, v82, s69
v_pk_add_f16 v83, v83, s69
v_pk_add_f16 v84, v84, s69
v_pk_add_f16 v85, v85, s69
v_rcp_f16_sdwa v78, v78 dst_sel:WORD_0 dst_unused:UNUSED_PRESERVE src0_sel:WORD_0
v_rcp_f16_sdwa v79, v79 dst_sel:WORD_0 dst_unused:UNUSED_PRESERVE src0_sel:WORD_0
v_rcp_f16_sdwa v80, v80 dst_sel:WORD_0 dst_unused:UNUSED_PRESERVE src0_sel:WORD_0
v_rcp_f16_sdwa v81, v81 dst_sel:WORD_0 dst_unused:UNUSED_PRESERVE src0_sel:WORD_0
v_rcp_f16_sdwa v82, v82 dst_sel:WORD_0 dst_unused:UNUSED_PRESERVE src0_sel:WORD_0
v_rcp_f16_sdwa v83, v83 dst_sel:WORD_0 dst_unused:UNUSED_PRESERVE src0_sel:WORD_0
v_rcp_f16_sdwa v84, v84 dst_sel:WORD_0 dst_unused:UNUSED_PRESERVE src0_sel:WORD_0
v_rcp_f16_sdwa v85, v85 dst_sel:WORD_0 dst_unused:UNUSED_PRESERVE src0_sel:WORD_0
s_waitcnt lgkmcnt(0)
v_add_u32_sdwa v117, v126, v116 dst_sel:DWORD dst_unused:UNUSED_PAD src0_sel:DWORD src1_sel:WORD_1
v_add_u32_sdwa v116, v126, v116 dst_sel:DWORD dst_unused:UNUSED_PAD src0_sel:DWORD src1_sel:WORD_0
s_add_u32 m0, s41, 2048
s_nop 0
buffer_load_dwordx4 v116, s[20:23], 0 offen nt lds
s_add_u32 m0, s41, 3072
s_nop 0
buffer_load_dwordx4 v117, s[20:23], 0 offen nt lds
s_waitcnt vmcnt(2)
ds_read_b128 v[94:97], v118 offset:0
ds_read_b128 v[98:101], v119 offset:0
v_rcp_f16_sdwa v78, v78 dst_sel:WORD_1 dst_unused:UNUSED_PRESERVE src0_sel:WORD_1
v_rcp_f16_sdwa v79, v79 dst_sel:WORD_1 dst_unused:UNUSED_PRESERVE src0_sel:WORD_1
v_rcp_f16_sdwa v80, v80 dst_sel:WORD_1 dst_unused:UNUSED_PRESERVE src0_sel:WORD_1
v_rcp_f16_sdwa v81, v81 dst_sel:WORD_1 dst_unused:UNUSED_PRESERVE src0_sel:WORD_1
v_rcp_f16_sdwa v82, v82 dst_sel:WORD_1 dst_unused:UNUSED_PRESERVE src0_sel:WORD_1
v_rcp_f16_sdwa v83, v83 dst_sel:WORD_1 dst_unused:UNUSED_PRESERVE src0_sel:WORD_1
v_rcp_f16_sdwa v84, v84 dst_sel:WORD_1 dst_unused:UNUSED_PRESERVE src0_sel:WORD_1
v_rcp_f16_sdwa v85, v85 dst_sel:WORD_1 dst_unused:UNUSED_PRESERVE src0_sel:WORD_1
s_cmp_le_u32 s43, 2
s_nop 0
v_mfma_f32_16x16x32_f16 v[114:117], v[78:81], v[66:69], v[74:77]
v_mfma_f32_16x16x32_f16 v[114:117], v[82:85], v[70:73], v[114:117]
s_cbranch_scc1 L_drain
s_waitcnt lgkmcnt(0)
v_mfma_f32_16x16x32_bf16 v[78:81], v[2:5], v[94:97], v[34:37]
v_mfma_f32_16x16x32_bf16 v[78:81], v[6:9], v[98:101], v[78:81]
v_mfma_f32_16x16x32_bf16 v[82:85], v[10:13], v[94:97], v[38:41]
v_mfma_f32_16x16x32_bf16 v[82:85], v[14:17], v[98:101], v[82:85]
v_mfma_f32_16x16x32_bf16 v[86:89], v[18:21], v[94:97], v[42:45]
v_mfma_f32_16x16x32_bf16 v[86:89], v[22:25], v[98:101], v[86:89]
v_mfma_f32_16x16x32_bf16 v[90:93], v[26:29], v[94:97], v[46:49]
v_mfma_f32_16x16x32_bf16 v[90:93], v[30:33], v[98:101], v[90:93]
s_setprio 2
v_cvt_pk_bf16_f32 v114, v114, v115
v_cvt_pk_bf16_f32 v115, v116, v117
v_exp_f32 v78, v78
v_exp_f32 v79, v79
v_exp_f32 v80, v80
v_exp_f32 v81, v81
v_mfma_f32_4x4x4_16b_bf16 v[50:53], v[114:115], v[102:103], v[50:53]
v_exp_f32 v82, v82
v_exp_f32 v83, v83
v_exp_f32 v84, v84
v_exp_f32 v85, v85
v_mfma_f32_4x4x4_16b_bf16 v[54:57], v[114:115], v[104:105], v[54:57]
v_exp_f32 v86, v86
v_exp_f32 v87, v87
v_exp_f32 v88, v88
v_exp_f32 v89, v89
v_mfma_f32_4x4x4_16b_bf16 v[58:61], v[114:115], v[106:107], v[58:61]
v_exp_f32 v90, v90
v_exp_f32 v91, v91
v_exp_f32 v92, v92
v_exp_f32 v93, v93
v_mfma_f32_4x4x4_16b_bf16 v[62:65], v[114:115], v[108:109], v[62:65]
ds_read_b64_tr_b16 v[102:103], v120 offset:0
ds_read_b64_tr_b16 v[104:105], v121 offset:0
ds_read_b64_tr_b16 v[106:107], v122 offset:0
ds_read_b64_tr_b16 v[108:109], v123 offset:0
ds_read_b32 v116, v124 offset:4224
v_cvt_pk_f16_f32 v78, v78, v79
v_cvt_pk_f16_f32 v79, v80, v81
v_cvt_pk_f16_f32 v80, v82, v83
v_cvt_pk_f16_f32 v81, v84, v85
v_cvt_pk_f16_f32 v82, v86, v87
v_cvt_pk_f16_f32 v83, v88, v89
v_cvt_pk_f16_f32 v84, v90, v91
v_cvt_pk_f16_f32 v85, v92, v93
v_pk_add_f16 v78, v78, s69
v_pk_add_f16 v79, v79, s69
v_pk_add_f16 v80, v80, s69
v_pk_add_f16 v81, v81, s69
v_pk_add_f16 v82, v82, s69
v_pk_add_f16 v83, v83, s69
v_pk_add_f16 v84, v84, s69
v_pk_add_f16 v85, v85, s69
v_rcp_f16_sdwa v78, v78 dst_sel:WORD_0 dst_unused:UNUSED_PRESERVE src0_sel:WORD_0
v_rcp_f16_sdwa v79, v79 dst_sel:WORD_0 dst_unused:UNUSED_PRESERVE src0_sel:WORD_0
v_rcp_f16_sdwa v80, v80 dst_sel:WORD_0 dst_unused:UNUSED_PRESERVE src0_sel:WORD_0
v_rcp_f16_sdwa v81, v81 dst_sel:WORD_0 dst_unused:UNUSED_PRESERVE src0_sel:WORD_0
v_rcp_f16_sdwa v82, v82 dst_sel:WORD_0 dst_unused:UNUSED_PRESERVE src0_sel:WORD_0
v_rcp_f16_sdwa v83, v83 dst_sel:WORD_0 dst_unused:UNUSED_PRESERVE src0_sel:WORD_0
v_rcp_f16_sdwa v84, v84 dst_sel:WORD_0 dst_unused:UNUSED_PRESERVE src0_sel:WORD_0
v_rcp_f16_sdwa v85, v85 dst_sel:WORD_0 dst_unused:UNUSED_PRESERVE src0_sel:WORD_0
s_waitcnt lgkmcnt(0)
v_add_u32_sdwa v117, v126, v116 dst_sel:DWORD dst_unused:UNUSED_PAD src0_sel:DWORD src1_sel:WORD_1
v_add_u32_sdwa v116, v126, v116 dst_sel:DWORD dst_unused:UNUSED_PAD src0_sel:DWORD src1_sel:WORD_0
s_add_u32 m0, s41, 0
s_nop 0
buffer_load_dwordx4 v116, s[20:23], 0 offen nt lds
s_add_u32 m0, s41, 1024
s_nop 0
buffer_load_dwordx4 v117, s[20:23], 0 offen nt lds
s_waitcnt vmcnt(2)
ds_read_b128 v[94:97], v118 offset:2048
ds_read_b128 v[98:101], v119 offset:2048
v_rcp_f16_sdwa v78, v78 dst_sel:WORD_1 dst_unused:UNUSED_PRESERVE src0_sel:WORD_1
v_rcp_f16_sdwa v79, v79 dst_sel:WORD_1 dst_unused:UNUSED_PRESERVE src0_sel:WORD_1
v_rcp_f16_sdwa v80, v80 dst_sel:WORD_1 dst_unused:UNUSED_PRESERVE src0_sel:WORD_1
v_rcp_f16_sdwa v81, v81 dst_sel:WORD_1 dst_unused:UNUSED_PRESERVE src0_sel:WORD_1
v_rcp_f16_sdwa v82, v82 dst_sel:WORD_1 dst_unused:UNUSED_PRESERVE src0_sel:WORD_1
v_rcp_f16_sdwa v83, v83 dst_sel:WORD_1 dst_unused:UNUSED_PRESERVE src0_sel:WORD_1
v_rcp_f16_sdwa v84, v84 dst_sel:WORD_1 dst_unused:UNUSED_PRESERVE src0_sel:WORD_1
v_rcp_f16_sdwa v85, v85 dst_sel:WORD_1 dst_unused:UNUSED_PRESERVE src0_sel:WORD_1
s_cmp_le_u32 s43, 3
s_nop 0
v_mfma_f32_16x16x32_f16 v[114:117], v[78:81], v[66:69], v[74:77]
v_mfma_f32_16x16x32_f16 v[114:117], v[82:85], v[70:73], v[114:117]
s_cbranch_scc1 L_drain
s_waitcnt lgkmcnt(0)
v_mfma_f32_16x16x32_bf16 v[78:81], v[2:5], v[94:97], v[34:37]
v_mfma_f32_16x16x32_bf16 v[78:81], v[6:9], v[98:101], v[78:81]
v_mfma_f32_16x16x32_bf16 v[82:85], v[10:13], v[94:97], v[38:41]
v_mfma_f32_16x16x32_bf16 v[82:85], v[14:17], v[98:101], v[82:85]
v_mfma_f32_16x16x32_bf16 v[86:89], v[18:21], v[94:97], v[42:45]
v_mfma_f32_16x16x32_bf16 v[86:89], v[22:25], v[98:101], v[86:89]
v_mfma_f32_16x16x32_bf16 v[90:93], v[26:29], v[94:97], v[46:49]
v_mfma_f32_16x16x32_bf16 v[90:93], v[30:33], v[98:101], v[90:93]
s_setprio 1
v_cvt_pk_bf16_f32 v114, v114, v115
v_cvt_pk_bf16_f32 v115, v116, v117
v_exp_f32 v78, v78
v_exp_f32 v79, v79
v_exp_f32 v80, v80
v_exp_f32 v81, v81
v_mfma_f32_4x4x4_16b_bf16 v[50:53], v[114:115], v[102:103], v[50:53]
v_exp_f32 v82, v82
v_exp_f32 v83, v83
v_exp_f32 v84, v84
v_exp_f32 v85, v85
v_mfma_f32_4x4x4_16b_bf16 v[54:57], v[114:115], v[104:105], v[54:57]
v_exp_f32 v86, v86
v_exp_f32 v87, v87
v_exp_f32 v88, v88
v_exp_f32 v89, v89
v_mfma_f32_4x4x4_16b_bf16 v[58:61], v[114:115], v[106:107], v[58:61]
v_exp_f32 v90, v90
v_exp_f32 v91, v91
v_exp_f32 v92, v92
v_exp_f32 v93, v93
v_mfma_f32_4x4x4_16b_bf16 v[62:65], v[114:115], v[108:109], v[62:65]
ds_read_b64_tr_b16 v[102:103], v120 offset:2048
ds_read_b64_tr_b16 v[104:105], v121 offset:2048
ds_read_b64_tr_b16 v[106:107], v122 offset:2048
ds_read_b64_tr_b16 v[108:109], v123 offset:2048
ds_read_b32 v116, v124 offset:4256
v_cvt_pk_f16_f32 v78, v78, v79
v_cvt_pk_f16_f32 v79, v80, v81
v_cvt_pk_f16_f32 v80, v82, v83
v_cvt_pk_f16_f32 v81, v84, v85
v_cvt_pk_f16_f32 v82, v86, v87
v_cvt_pk_f16_f32 v83, v88, v89
v_cvt_pk_f16_f32 v84, v90, v91
v_cvt_pk_f16_f32 v85, v92, v93
v_pk_add_f16 v78, v78, s69
v_pk_add_f16 v79, v79, s69
v_pk_add_f16 v80, v80, s69
v_pk_add_f16 v81, v81, s69
v_pk_add_f16 v82, v82, s69
v_pk_add_f16 v83, v83, s69
v_pk_add_f16 v84, v84, s69
v_pk_add_f16 v85, v85, s69
v_rcp_f16_sdwa v78, v78 dst_sel:WORD_0 dst_unused:UNUSED_PRESERVE src0_sel:WORD_0
v_rcp_f16_sdwa v79, v79 dst_sel:WORD_0 dst_unused:UNUSED_PRESERVE src0_sel:WORD_0
v_rcp_f16_sdwa v80, v80 dst_sel:WORD_0 dst_unused:UNUSED_PRESERVE src0_sel:WORD_0
v_rcp_f16_sdwa v81, v81 dst_sel:WORD_0 dst_unused:UNUSED_PRESERVE src0_sel:WORD_0
v_rcp_f16_sdwa v82, v82 dst_sel:WORD_0 dst_unused:UNUSED_PRESERVE src0_sel:WORD_0
v_rcp_f16_sdwa v83, v83 dst_sel:WORD_0 dst_unused:UNUSED_PRESERVE src0_sel:WORD_0
v_rcp_f16_sdwa v84, v84 dst_sel:WORD_0 dst_unused:UNUSED_PRESERVE src0_sel:WORD_0
v_rcp_f16_sdwa v85, v85 dst_sel:WORD_0 dst_unused:UNUSED_PRESERVE src0_sel:WORD_0
s_waitcnt lgkmcnt(0)
v_add_u32_sdwa v117, v126, v116 dst_sel:DWORD dst_unused:UNUSED_PAD src0_sel:DWORD src1_sel:WORD_1
v_add_u32_sdwa v116, v126, v116 dst_sel:DWORD dst_unused:UNUSED_PAD src0_sel:DWORD src1_sel:WORD_0
s_add_u32 m0, s41, 2048
s_nop 0
buffer_load_dwordx4 v116, s[20:23], 0 offen nt lds
s_add_u32 m0, s41, 3072
s_nop 0
buffer_load_dwordx4 v117, s[20:23], 0 offen nt lds
s_waitcnt vmcnt(2)
ds_read_b128 v[94:97], v118 offset:0
ds_read_b128 v[98:101], v119 offset:0
v_rcp_f16_sdwa v78, v78 dst_sel:WORD_1 dst_unused:UNUSED_PRESERVE src0_sel:WORD_1
v_rcp_f16_sdwa v79, v79 dst_sel:WORD_1 dst_unused:UNUSED_PRESERVE src0_sel:WORD_1
v_rcp_f16_sdwa v80, v80 dst_sel:WORD_1 dst_unused:UNUSED_PRESERVE src0_sel:WORD_1
v_rcp_f16_sdwa v81, v81 dst_sel:WORD_1 dst_unused:UNUSED_PRESERVE src0_sel:WORD_1
v_rcp_f16_sdwa v82, v82 dst_sel:WORD_1 dst_unused:UNUSED_PRESERVE src0_sel:WORD_1
v_rcp_f16_sdwa v83, v83 dst_sel:WORD_1 dst_unused:UNUSED_PRESERVE src0_sel:WORD_1
v_rcp_f16_sdwa v84, v84 dst_sel:WORD_1 dst_unused:UNUSED_PRESERVE src0_sel:WORD_1
v_rcp_f16_sdwa v85, v85 dst_sel:WORD_1 dst_unused:UNUSED_PRESERVE src0_sel:WORD_1
s_cmp_le_u32 s43, 4
s_nop 0
v_mfma_f32_16x16x32_f16 v[114:117], v[78:81], v[66:69], v[74:77]
v_mfma_f32_16x16x32_f16 v[114:117], v[82:85], v[70:73], v[114:117]
s_cbranch_scc1 L_drain
s_waitcnt lgkmcnt(0)
v_mfma_f32_16x16x32_bf16 v[78:81], v[2:5], v[94:97], v[34:37]
v_mfma_f32_16x16x32_bf16 v[78:81], v[6:9], v[98:101], v[78:81]
v_mfma_f32_16x16x32_bf16 v[82:85], v[10:13], v[94:97], v[38:41]
v_mfma_f32_16x16x32_bf16 v[82:85], v[14:17], v[98:101], v[82:85]
v_mfma_f32_16x16x32_bf16 v[86:89], v[18:21], v[94:97], v[42:45]
v_mfma_f32_16x16x32_bf16 v[86:89], v[22:25], v[98:101], v[86:89]
v_mfma_f32_16x16x32_bf16 v[90:93], v[26:29], v[94:97], v[46:49]
v_mfma_f32_16x16x32_bf16 v[90:93], v[30:33], v[98:101], v[90:93]
s_setprio 2
v_cvt_pk_bf16_f32 v114, v114, v115
v_cvt_pk_bf16_f32 v115, v116, v117
v_exp_f32 v78, v78
v_exp_f32 v79, v79
v_exp_f32 v80, v80
v_exp_f32 v81, v81
v_mfma_f32_4x4x4_16b_bf16 v[50:53], v[114:115], v[102:103], v[50:53]
v_exp_f32 v82, v82
v_exp_f32 v83, v83
v_exp_f32 v84, v84
v_exp_f32 v85, v85
v_mfma_f32_4x4x4_16b_bf16 v[54:57], v[114:115], v[104:105], v[54:57]
v_exp_f32 v86, v86
v_exp_f32 v87, v87
v_exp_f32 v88, v88
v_exp_f32 v89, v89
v_mfma_f32_4x4x4_16b_bf16 v[58:61], v[114:115], v[106:107], v[58:61]
v_exp_f32 v90, v90
v_exp_f32 v91, v91
v_exp_f32 v92, v92
v_exp_f32 v93, v93
v_mfma_f32_4x4x4_16b_bf16 v[62:65], v[114:115], v[108:109], v[62:65]
ds_read_b64_tr_b16 v[102:103], v120 offset:0
ds_read_b64_tr_b16 v[104:105], v121 offset:0
ds_read_b64_tr_b16 v[106:107], v122 offset:0
ds_read_b64_tr_b16 v[108:109], v123 offset:0
ds_read_b32 v116, v124 offset:4288
v_cvt_pk_f16_f32 v78, v78, v79
v_cvt_pk_f16_f32 v79, v80, v81
v_cvt_pk_f16_f32 v80, v82, v83
v_cvt_pk_f16_f32 v81, v84, v85
v_cvt_pk_f16_f32 v82, v86, v87
v_cvt_pk_f16_f32 v83, v88, v89
v_cvt_pk_f16_f32 v84, v90, v91
v_cvt_pk_f16_f32 v85, v92, v93
v_pk_add_f16 v78, v78, s69
v_pk_add_f16 v79, v79, s69
v_pk_add_f16 v80, v80, s69
v_pk_add_f16 v81, v81, s69
v_pk_add_f16 v82, v82, s69
v_pk_add_f16 v83, v83, s69
v_pk_add_f16 v84, v84, s69
v_pk_add_f16 v85, v85, s69
v_rcp_f16_sdwa v78, v78 dst_sel:WORD_0 dst_unused:UNUSED_PRESERVE src0_sel:WORD_0
v_rcp_f16_sdwa v79, v79 dst_sel:WORD_0 dst_unused:UNUSED_PRESERVE src0_sel:WORD_0
v_rcp_f16_sdwa v80, v80 dst_sel:WORD_0 dst_unused:UNUSED_PRESERVE src0_sel:WORD_0
v_rcp_f16_sdwa v81, v81 dst_sel:WORD_0 dst_unused:UNUSED_PRESERVE src0_sel:WORD_0
v_rcp_f16_sdwa v82, v82 dst_sel:WORD_0 dst_unused:UNUSED_PRESERVE src0_sel:WORD_0
v_rcp_f16_sdwa v83, v83 dst_sel:WORD_0 dst_unused:UNUSED_PRESERVE src0_sel:WORD_0
v_rcp_f16_sdwa v84, v84 dst_sel:WORD_0 dst_unused:UNUSED_PRESERVE src0_sel:WORD_0
v_rcp_f16_sdwa v85, v85 dst_sel:WORD_0 dst_unused:UNUSED_PRESERVE src0_sel:WORD_0
s_waitcnt lgkmcnt(0)
v_add_u32_sdwa v117, v126, v116 dst_sel:DWORD dst_unused:UNUSED_PAD src0_sel:DWORD src1_sel:WORD_1
v_add_u32_sdwa v116, v126, v116 dst_sel:DWORD dst_unused:UNUSED_PAD src0_sel:DWORD src1_sel:WORD_0
s_add_u32 m0, s41, 0
s_nop 0
buffer_load_dwordx4 v116, s[20:23], 0 offen nt lds
s_add_u32 m0, s41, 1024
s_nop 0
buffer_load_dwordx4 v117, s[20:23], 0 offen nt lds
s_waitcnt vmcnt(2)
ds_read_b128 v[94:97], v118 offset:2048
ds_read_b128 v[98:101], v119 offset:2048
v_rcp_f16_sdwa v78, v78 dst_sel:WORD_1 dst_unused:UNUSED_PRESERVE src0_sel:WORD_1
v_rcp_f16_sdwa v79, v79 dst_sel:WORD_1 dst_unused:UNUSED_PRESERVE src0_sel:WORD_1
v_rcp_f16_sdwa v80, v80 dst_sel:WORD_1 dst_unused:UNUSED_PRESERVE src0_sel:WORD_1
v_rcp_f16_sdwa v81, v81 dst_sel:WORD_1 dst_unused:UNUSED_PRESERVE src0_sel:WORD_1
v_rcp_f16_sdwa v82, v82 dst_sel:WORD_1 dst_unused:UNUSED_PRESERVE src0_sel:WORD_1
v_rcp_f16_sdwa v83, v83 dst_sel:WORD_1 dst_unused:UNUSED_PRESERVE src0_sel:WORD_1
v_rcp_f16_sdwa v84, v84 dst_sel:WORD_1 dst_unused:UNUSED_PRESERVE src0_sel:WORD_1
v_rcp_f16_sdwa v85, v85 dst_sel:WORD_1 dst_unused:UNUSED_PRESERVE src0_sel:WORD_1
s_cmp_le_u32 s43, 5
s_nop 0
v_mfma_f32_16x16x32_f16 v[114:117], v[78:81], v[66:69], v[74:77]
v_mfma_f32_16x16x32_f16 v[114:117], v[82:85], v[70:73], v[114:117]
s_cbranch_scc1 L_drain
s_waitcnt lgkmcnt(0)
v_mfma_f32_16x16x32_bf16 v[78:81], v[2:5], v[94:97], v[34:37]
v_mfma_f32_16x16x32_bf16 v[78:81], v[6:9], v[98:101], v[78:81]
v_mfma_f32_16x16x32_bf16 v[82:85], v[10:13], v[94:97], v[38:41]
v_mfma_f32_16x16x32_bf16 v[82:85], v[14:17], v[98:101], v[82:85]
v_mfma_f32_16x16x32_bf16 v[86:89], v[18:21], v[94:97], v[42:45]
v_mfma_f32_16x16x32_bf16 v[86:89], v[22:25], v[98:101], v[86:89]
v_mfma_f32_16x16x32_bf16 v[90:93], v[26:29], v[94:97], v[46:49]
v_mfma_f32_16x16x32_bf16 v[90:93], v[30:33], v[98:101], v[90:93]
s_setprio 1
v_cvt_pk_bf16_f32 v114, v114, v115
v_cvt_pk_bf16_f32 v115, v116, v117
v_exp_f32 v78, v78
v_exp_f32 v79, v79
v_exp_f32 v80, v80
v_exp_f32 v81, v81
v_mfma_f32_4x4x4_16b_bf16 v[50:53], v[114:115], v[102:103], v[50:53]
v_exp_f32 v82, v82
v_exp_f32 v83, v83
v_exp_f32 v84, v84
v_exp_f32 v85, v85
v_mfma_f32_4x4x4_16b_bf16 v[54:57], v[114:115], v[104:105], v[54:57]
v_exp_f32 v86, v86
v_exp_f32 v87, v87
v_exp_f32 v88, v88
v_exp_f32 v89, v89
v_mfma_f32_4x4x4_16b_bf16 v[58:61], v[114:115], v[106:107], v[58:61]
v_exp_f32 v90, v90
v_exp_f32 v91, v91
v_exp_f32 v92, v92
v_exp_f32 v93, v93
v_mfma_f32_4x4x4_16b_bf16 v[62:65], v[114:115], v[108:109], v[62:65]
ds_read_b64_tr_b16 v[102:103], v120 offset:2048
ds_read_b64_tr_b16 v[104:105], v121 offset:2048
ds_read_b64_tr_b16 v[106:107], v122 offset:2048
ds_read_b64_tr_b16 v[108:109], v123 offset:2048
ds_read_b32 v116, v124 offset:4320
v_cvt_pk_f16_f32 v78, v78, v79
v_cvt_pk_f16_f32 v79, v80, v81
v_cvt_pk_f16_f32 v80, v82, v83
v_cvt_pk_f16_f32 v81, v84, v85
v_cvt_pk_f16_f32 v82, v86, v87
v_cvt_pk_f16_f32 v83, v88, v89
v_cvt_pk_f16_f32 v84, v90, v91
v_cvt_pk_f16_f32 v85, v92, v93
v_pk_add_f16 v78, v78, s69
v_pk_add_f16 v79, v79, s69
v_pk_add_f16 v80, v80, s69
v_pk_add_f16 v81, v81, s69
v_pk_add_f16 v82, v82, s69
v_pk_add_f16 v83, v83, s69
v_pk_add_f16 v84, v84, s69
v_pk_add_f16 v85, v85, s69
v_rcp_f16_sdwa v78, v78 dst_sel:WORD_0 dst_unused:UNUSED_PRESERVE src0_sel:WORD_0
v_rcp_f16_sdwa v79, v79 dst_sel:WORD_0 dst_unused:UNUSED_PRESERVE src0_sel:WORD_0
v_rcp_f16_sdwa v80, v80 dst_sel:WORD_0 dst_unused:UNUSED_PRESERVE src0_sel:WORD_0
v_rcp_f16_sdwa v81, v81 dst_sel:WORD_0 dst_unused:UNUSED_PRESERVE src0_sel:WORD_0
v_rcp_f16_sdwa v82, v82 dst_sel:WORD_0 dst_unused:UNUSED_PRESERVE src0_sel:WORD_0
v_rcp_f16_sdwa v83, v83 dst_sel:WORD_0 dst_unused:UNUSED_PRESERVE src0_sel:WORD_0
v_rcp_f16_sdwa v84, v84 dst_sel:WORD_0 dst_unused:UNUSED_PRESERVE src0_sel:WORD_0
v_rcp_f16_sdwa v85, v85 dst_sel:WORD_0 dst_unused:UNUSED_PRESERVE src0_sel:WORD_0
s_waitcnt lgkmcnt(0)
v_add_u32_sdwa v117, v126, v116 dst_sel:DWORD dst_unused:UNUSED_PAD src0_sel:DWORD src1_sel:WORD_1
v_add_u32_sdwa v116, v126, v116 dst_sel:DWORD dst_unused:UNUSED_PAD src0_sel:DWORD src1_sel:WORD_0
s_add_u32 m0, s41, 2048
s_nop 0
buffer_load_dwordx4 v116, s[20:23], 0 offen nt lds
s_add_u32 m0, s41, 3072
s_nop 0
buffer_load_dwordx4 v117, s[20:23], 0 offen nt lds
s_waitcnt vmcnt(2)
ds_read_b128 v[94:97], v118 offset:0
ds_read_b128 v[98:101], v119 offset:0
v_rcp_f16_sdwa v78, v78 dst_sel:WORD_1 dst_unused:UNUSED_PRESERVE src0_sel:WORD_1
v_rcp_f16_sdwa v79, v79 dst_sel:WORD_1 dst_unused:UNUSED_PRESERVE src0_sel:WORD_1
v_rcp_f16_sdwa v80, v80 dst_sel:WORD_1 dst_unused:UNUSED_PRESERVE src0_sel:WORD_1
v_rcp_f16_sdwa v81, v81 dst_sel:WORD_1 dst_unused:UNUSED_PRESERVE src0_sel:WORD_1
v_rcp_f16_sdwa v82, v82 dst_sel:WORD_1 dst_unused:UNUSED_PRESERVE src0_sel:WORD_1
v_rcp_f16_sdwa v83, v83 dst_sel:WORD_1 dst_unused:UNUSED_PRESERVE src0_sel:WORD_1
v_rcp_f16_sdwa v84, v84 dst_sel:WORD_1 dst_unused:UNUSED_PRESERVE src0_sel:WORD_1
v_rcp_f16_sdwa v85, v85 dst_sel:WORD_1 dst_unused:UNUSED_PRESERVE src0_sel:WORD_1
s_cmp_le_u32 s43, 6
s_nop 0
v_mfma_f32_16x16x32_f16 v[114:117], v[78:81], v[66:69], v[74:77]
v_mfma_f32_16x16x32_f16 v[114:117], v[82:85], v[70:73], v[114:117]
s_cbranch_scc1 L_drain
s_waitcnt lgkmcnt(0)
v_mfma_f32_16x16x32_bf16 v[78:81], v[2:5], v[94:97], v[34:37]
v_mfma_f32_16x16x32_bf16 v[78:81], v[6:9], v[98:101], v[78:81]
v_mfma_f32_16x16x32_bf16 v[82:85], v[10:13], v[94:97], v[38:41]
v_mfma_f32_16x16x32_bf16 v[82:85], v[14:17], v[98:101], v[82:85]
v_mfma_f32_16x16x32_bf16 v[86:89], v[18:21], v[94:97], v[42:45]
v_mfma_f32_16x16x32_bf16 v[86:89], v[22:25], v[98:101], v[86:89]
v_mfma_f32_16x16x32_bf16 v[90:93], v[26:29], v[94:97], v[46:49]
v_mfma_f32_16x16x32_bf16 v[90:93], v[30:33], v[98:101], v[90:93]
s_setprio 0
v_cvt_pk_bf16_f32 v114, v114, v115
v_cvt_pk_bf16_f32 v115, v116, v117
v_exp_f32 v78, v78
v_exp_f32 v79, v79
v_exp_f32 v80, v80
v_exp_f32 v81, v81
v_mfma_f32_4x4x4_16b_bf16 v[50:53], v[114:115], v[102:103], v[50:53]
v_exp_f32 v82, v82
v_exp_f32 v83, v83
v_exp_f32 v84, v84
v_exp_f32 v85, v85
v_mfma_f32_4x4x4_16b_bf16 v[54:57], v[114:115], v[104:105], v[54:57]
v_exp_f32 v86, v86
v_exp_f32 v87, v87
v_exp_f32 v88, v88
v_exp_f32 v89, v89
v_mfma_f32_4x4x4_16b_bf16 v[58:61], v[114:115], v[106:107], v[58:61]
v_exp_f32 v90, v90
v_exp_f32 v91, v91
v_exp_f32 v92, v92
v_exp_f32 v93, v93
v_mfma_f32_4x4x4_16b_bf16 v[62:65], v[114:115], v[108:109], v[62:65]
ds_read_b64_tr_b16 v[102:103], v120 offset:0
ds_read_b64_tr_b16 v[104:105], v121 offset:0
ds_read_b64_tr_b16 v[106:107], v122 offset:0
ds_read_b64_tr_b16 v[108:109], v123 offset:0
ds_read_b32 v116, v124 offset:4352
v_cvt_pk_f16_f32 v78, v78, v79
v_cvt_pk_f16_f32 v79, v80, v81
v_cvt_pk_f16_f32 v80, v82, v83
v_cvt_pk_f16_f32 v81, v84, v85
v_cvt_pk_f16_f32 v82, v86, v87
v_cvt_pk_f16_f32 v83, v88, v89
v_cvt_pk_f16_f32 v84, v90, v91
v_cvt_pk_f16_f32 v85, v92, v93
v_pk_add_f16 v78, v78, s69
v_pk_add_f16 v79, v79, s69
v_pk_add_f16 v80, v80, s69
v_pk_add_f16 v81, v81, s69
v_pk_add_f16 v82, v82, s69
v_pk_add_f16 v83, v83, s69
v_pk_add_f16 v84, v84, s69
v_pk_add_f16 v85, v85, s69
v_rcp_f16_sdwa v78, v78 dst_sel:WORD_0 dst_unused:UNUSED_PRESERVE src0_sel:WORD_0
v_rcp_f16_sdwa v79, v79 dst_sel:WORD_0 dst_unused:UNUSED_PRESERVE src0_sel:WORD_0
v_rcp_f16_sdwa v80, v80 dst_sel:WORD_0 dst_unused:UNUSED_PRESERVE src0_sel:WORD_0
v_rcp_f16_sdwa v81, v81 dst_sel:WORD_0 dst_unused:UNUSED_PRESERVE src0_sel:WORD_0
v_rcp_f16_sdwa v82, v82 dst_sel:WORD_0 dst_unused:UNUSED_PRESERVE src0_sel:WORD_0
v_rcp_f16_sdwa v83, v83 dst_sel:WORD_0 dst_unused:UNUSED_PRESERVE src0_sel:WORD_0
v_rcp_f16_sdwa v84, v84 dst_sel:WORD_0 dst_unused:UNUSED_PRESERVE src0_sel:WORD_0
v_rcp_f16_sdwa v85, v85 dst_sel:WORD_0 dst_unused:UNUSED_PRESERVE src0_sel:WORD_0
s_waitcnt lgkmcnt(0)
v_add_u32_sdwa v117, v126, v116 dst_sel:DWORD dst_unused:UNUSED_PAD src0_sel:DWORD src1_sel:WORD_1
v_add_u32_sdwa v116, v126, v116 dst_sel:DWORD dst_unused:UNUSED_PAD src0_sel:DWORD src1_sel:WORD_0
s_add_u32 m0, s41, 0
s_nop 0
buffer_load_dwordx4 v116, s[20:23], 0 offen nt lds
s_add_u32 m0, s41, 1024
s_nop 0
buffer_load_dwordx4 v117, s[20:23], 0 offen nt lds
s_waitcnt vmcnt(2)
ds_read_b128 v[94:97], v118 offset:2048
ds_read_b128 v[98:101], v119 offset:2048
v_rcp_f16_sdwa v78, v78 dst_sel:WORD_1 dst_unused:UNUSED_PRESERVE src0_sel:WORD_1
v_rcp_f16_sdwa v79, v79 dst_sel:WORD_1 dst_unused:UNUSED_PRESERVE src0_sel:WORD_1
v_rcp_f16_sdwa v80, v80 dst_sel:WORD_1 dst_unused:UNUSED_PRESERVE src0_sel:WORD_1
v_rcp_f16_sdwa v81, v81 dst_sel:WORD_1 dst_unused:UNUSED_PRESERVE src0_sel:WORD_1
v_rcp_f16_sdwa v82, v82 dst_sel:WORD_1 dst_unused:UNUSED_PRESERVE src0_sel:WORD_1
v_rcp_f16_sdwa v83, v83 dst_sel:WORD_1 dst_unused:UNUSED_PRESERVE src0_sel:WORD_1
v_rcp_f16_sdwa v84, v84 dst_sel:WORD_1 dst_unused:UNUSED_PRESERVE src0_sel:WORD_1
v_rcp_f16_sdwa v85, v85 dst_sel:WORD_1 dst_unused:UNUSED_PRESERVE src0_sel:WORD_1
s_cmp_le_u32 s43, 7
s_nop 0
v_mfma_f32_16x16x32_f16 v[114:117], v[78:81], v[66:69], v[74:77]
v_mfma_f32_16x16x32_f16 v[114:117], v[82:85], v[70:73], v[114:117]
s_cbranch_scc1 L_drain
s_waitcnt lgkmcnt(0)
v_mfma_f32_16x16x32_bf16 v[78:81], v[2:5], v[94:97], v[34:37]
v_mfma_f32_16x16x32_bf16 v[78:81], v[6:9], v[98:101], v[78:81]
v_mfma_f32_16x16x32_bf16 v[82:85], v[10:13], v[94:97], v[38:41]
v_mfma_f32_16x16x32_bf16 v[82:85], v[14:17], v[98:101], v[82:85]
v_mfma_f32_16x16x32_bf16 v[86:89], v[18:21], v[94:97], v[42:45]
v_mfma_f32_16x16x32_bf16 v[86:89], v[22:25], v[98:101], v[86:89]
v_mfma_f32_16x16x32_bf16 v[90:93], v[26:29], v[94:97], v[46:49]
v_mfma_f32_16x16x32_bf16 v[90:93], v[30:33], v[98:101], v[90:93]
v_cvt_pk_bf16_f32 v114, v114, v115
v_cvt_pk_bf16_f32 v115, v116, v117
v_exp_f32 v78, v78
v_exp_f32 v79, v79
v_exp_f32 v80, v80
v_exp_f32 v81, v81
v_mfma_f32_4x4x4_16b_bf16 v[50:53], v[114:115], v[102:103], v[50:53]
v_exp_f32 v82, v82
v_exp_f32 v83, v83
v_exp_f32 v84, v84
v_exp_f32 v85, v85
v_mfma_f32_4x4x4_16b_bf16 v[54:57], v[114:115], v[104:105], v[54:57]
v_exp_f32 v86, v86
v_exp_f32 v87, v87
v_exp_f32 v88, v88
v_exp_f32 v89, v89
v_mfma_f32_4x4x4_16b_bf16 v[58:61], v[114:115], v[106:107], v[58:61]
v_exp_f32 v90, v90
v_exp_f32 v91, v91
v_exp_f32 v92, v92
v_exp_f32 v93, v93
v_mfma_f32_4x4x4_16b_bf16 v[62:65], v[114:115], v[108:109], v[62:65]
ds_read_b64_tr_b16 v[102:103], v120 offset:2048
ds_read_b64_tr_b16 v[104:105], v121 offset:2048
ds_read_b64_tr_b16 v[106:107], v122 offset:2048
ds_read_b64_tr_b16 v[108:109], v123 offset:2048
ds_read_b32 v116, v124 offset:4384
v_cvt_pk_f16_f32 v78, v78, v79
v_cvt_pk_f16_f32 v79, v80, v81
v_cvt_pk_f16_f32 v80, v82, v83
v_cvt_pk_f16_f32 v81, v84, v85
v_cvt_pk_f16_f32 v82, v86, v87
v_cvt_pk_f16_f32 v83, v88, v89
v_cvt_pk_f16_f32 v84, v90, v91
v_cvt_pk_f16_f32 v85, v92, v93
v_pk_add_f16 v78, v78, s69
v_pk_add_f16 v79, v79, s69
v_pk_add_f16 v80, v80, s69
v_pk_add_f16 v81, v81, s69
v_pk_add_f16 v82, v82, s69
v_pk_add_f16 v83, v83, s69
v_pk_add_f16 v84, v84, s69
v_pk_add_f16 v85, v85, s69
v_rcp_f16_sdwa v78, v78 dst_sel:WORD_0 dst_unused:UNUSED_PRESERVE src0_sel:WORD_0
v_rcp_f16_sdwa v79, v79 dst_sel:WORD_0 dst_unused:UNUSED_PRESERVE src0_sel:WORD_0
v_rcp_f16_sdwa v80, v80 dst_sel:WORD_0 dst_unused:UNUSED_PRESERVE src0_sel:WORD_0
v_rcp_f16_sdwa v81, v81 dst_sel:WORD_0 dst_unused:UNUSED_PRESERVE src0_sel:WORD_0
v_rcp_f16_sdwa v82, v82 dst_sel:WORD_0 dst_unused:UNUSED_PRESERVE src0_sel:WORD_0
v_rcp_f16_sdwa v83, v83 dst_sel:WORD_0 dst_unused:UNUSED_PRESERVE src0_sel:WORD_0
v_rcp_f16_sdwa v84, v84 dst_sel:WORD_0 dst_unused:UNUSED_PRESERVE src0_sel:WORD_0
v_rcp_f16_sdwa v85, v85 dst_sel:WORD_0 dst_unused:UNUSED_PRESERVE src0_sel:WORD_0
s_waitcnt lgkmcnt(0)
v_add_u32_sdwa v117, v126, v116 dst_sel:DWORD dst_unused:UNUSED_PAD src0_sel:DWORD src1_sel:WORD_1
v_add_u32_sdwa v116, v126, v116 dst_sel:DWORD dst_unused:UNUSED_PAD src0_sel:DWORD src1_sel:WORD_0
s_add_u32 m0, s41, 2048
s_nop 0
buffer_load_dwordx4 v116, s[20:23], 0 offen nt lds
s_add_u32 m0, s41, 3072
s_nop 0
buffer_load_dwordx4 v117, s[20:23], 0 offen nt lds
s_waitcnt vmcnt(2)
ds_read_b128 v[94:97], v118 offset:0
ds_read_b128 v[98:101], v119 offset:0
v_rcp_f16_sdwa v78, v78 dst_sel:WORD_1 dst_unused:UNUSED_PRESERVE src0_sel:WORD_1
v_rcp_f16_sdwa v79, v79 dst_sel:WORD_1 dst_unused:UNUSED_PRESERVE src0_sel:WORD_1
v_rcp_f16_sdwa v80, v80 dst_sel:WORD_1 dst_unused:UNUSED_PRESERVE src0_sel:WORD_1
v_rcp_f16_sdwa v81, v81 dst_sel:WORD_1 dst_unused:UNUSED_PRESERVE src0_sel:WORD_1
v_rcp_f16_sdwa v82, v82 dst_sel:WORD_1 dst_unused:UNUSED_PRESERVE src0_sel:WORD_1
v_rcp_f16_sdwa v83, v83 dst_sel:WORD_1 dst_unused:UNUSED_PRESERVE src0_sel:WORD_1
v_rcp_f16_sdwa v84, v84 dst_sel:WORD_1 dst_unused:UNUSED_PRESERVE src0_sel:WORD_1
v_rcp_f16_sdwa v85, v85 dst_sel:WORD_1 dst_unused:UNUSED_PRESERVE src0_sel:WORD_1
s_cmp_le_u32 s43, 8
s_nop 0
v_mfma_f32_16x16x32_f16 v[114:117], v[78:81], v[66:69], v[74:77]
v_mfma_f32_16x16x32_f16 v[114:117], v[82:85], v[70:73], v[114:117]
s_cbranch_scc1 L_drain
s_waitcnt lgkmcnt(0)
v_mfma_f32_16x16x32_bf16 v[78:81], v[2:5], v[94:97], v[34:37]
v_mfma_f32_16x16x32_bf16 v[78:81], v[6:9], v[98:101], v[78:81]
v_mfma_f32_16x16x32_bf16 v[82:85], v[10:13], v[94:97], v[38:41]
v_mfma_f32_16x16x32_bf16 v[82:85], v[14:17], v[98:101], v[82:85]
v_mfma_f32_16x16x32_bf16 v[86:89], v[18:21], v[94:97], v[42:45]
v_mfma_f32_16x16x32_bf16 v[86:89], v[22:25], v[98:101], v[86:89]
v_mfma_f32_16x16x32_bf16 v[90:93], v[26:29], v[94:97], v[46:49]
v_mfma_f32_16x16x32_bf16 v[90:93], v[30:33], v[98:101], v[90:93]
v_cvt_pk_bf16_f32 v114, v114, v115
v_cvt_pk_bf16_f32 v115, v116, v117
v_exp_f32 v78, v78
v_exp_f32 v79, v79
v_exp_f32 v80, v80
v_exp_f32 v81, v81
v_mfma_f32_4x4x4_16b_bf16 v[50:53], v[114:115], v[102:103], v[50:53]
v_exp_f32 v82, v82
v_exp_f32 v83, v83
v_exp_f32 v84, v84
v_exp_f32 v85, v85
v_mfma_f32_4x4x4_16b_bf16 v[54:57], v[114:115], v[104:105], v[54:57]
v_exp_f32 v86, v86
v_exp_f32 v87, v87
v_exp_f32 v88, v88
v_exp_f32 v89, v89
v_mfma_f32_4x4x4_16b_bf16 v[58:61], v[114:115], v[106:107], v[58:61]
v_exp_f32 v90, v90
v_exp_f32 v91, v91
v_exp_f32 v92, v92
v_exp_f32 v93, v93
v_mfma_f32_4x4x4_16b_bf16 v[62:65], v[114:115], v[108:109], v[62:65]
ds_read_b64_tr_b16 v[102:103], v120 offset:0
ds_read_b64_tr_b16 v[104:105], v121 offset:0
ds_read_b64_tr_b16 v[106:107], v122 offset:0
ds_read_b64_tr_b16 v[108:109], v123 offset:0
ds_read_b32 v116, v124 offset:4416
v_cvt_pk_f16_f32 v78, v78, v79
v_cvt_pk_f16_f32 v79, v80, v81
v_cvt_pk_f16_f32 v80, v82, v83
v_cvt_pk_f16_f32 v81, v84, v85
v_cvt_pk_f16_f32 v82, v86, v87
v_cvt_pk_f16_f32 v83, v88, v89
v_cvt_pk_f16_f32 v84, v90, v91
v_cvt_pk_f16_f32 v85, v92, v93
v_pk_add_f16 v78, v78, s69
v_pk_add_f16 v79, v79, s69
v_pk_add_f16 v80, v80, s69
v_pk_add_f16 v81, v81, s69
v_pk_add_f16 v82, v82, s69
v_pk_add_f16 v83, v83, s69
v_pk_add_f16 v84, v84, s69
v_pk_add_f16 v85, v85, s69
v_rcp_f16_sdwa v78, v78 dst_sel:WORD_0 dst_unused:UNUSED_PRESERVE src0_sel:WORD_0
v_rcp_f16_sdwa v79, v79 dst_sel:WORD_0 dst_unused:UNUSED_PRESERVE src0_sel:WORD_0
v_rcp_f16_sdwa v80, v80 dst_sel:WORD_0 dst_unused:UNUSED_PRESERVE src0_sel:WORD_0
v_rcp_f16_sdwa v81, v81 dst_sel:WORD_0 dst_unused:UNUSED_PRESERVE src0_sel:WORD_0
v_rcp_f16_sdwa v82, v82 dst_sel:WORD_0 dst_unused:UNUSED_PRESERVE src0_sel:WORD_0
v_rcp_f16_sdwa v83, v83 dst_sel:WORD_0 dst_unused:UNUSED_PRESERVE src0_sel:WORD_0
v_rcp_f16_sdwa v84, v84 dst_sel:WORD_0 dst_unused:UNUSED_PRESERVE src0_sel:WORD_0
v_rcp_f16_sdwa v85, v85 dst_sel:WORD_0 dst_unused:UNUSED_PRESERVE src0_sel:WORD_0
s_waitcnt lgkmcnt(0)
v_add_u32_sdwa v117, v126, v116 dst_sel:DWORD dst_unused:UNUSED_PAD src0_sel:DWORD src1_sel:WORD_1
v_add_u32_sdwa v116, v126, v116 dst_sel:DWORD dst_unused:UNUSED_PAD src0_sel:DWORD src1_sel:WORD_0
s_add_u32 m0, s41, 0
s_nop 0
buffer_load_dwordx4 v116, s[20:23], 0 offen nt lds
s_add_u32 m0, s41, 1024
s_nop 0
buffer_load_dwordx4 v117, s[20:23], 0 offen nt lds
s_waitcnt vmcnt(2)
ds_read_b128 v[94:97], v118 offset:2048
ds_read_b128 v[98:101], v119 offset:2048
v_rcp_f16_sdwa v78, v78 dst_sel:WORD_1 dst_unused:UNUSED_PRESERVE src0_sel:WORD_1
v_rcp_f16_sdwa v79, v79 dst_sel:WORD_1 dst_unused:UNUSED_PRESERVE src0_sel:WORD_1
v_rcp_f16_sdwa v80, v80 dst_sel:WORD_1 dst_unused:UNUSED_PRESERVE src0_sel:WORD_1
v_rcp_f16_sdwa v81, v81 dst_sel:WORD_1 dst_unused:UNUSED_PRESERVE src0_sel:WORD_1
v_rcp_f16_sdwa v82, v82 dst_sel:WORD_1 dst_unused:UNUSED_PRESERVE src0_sel:WORD_1
v_rcp_f16_sdwa v83, v83 dst_sel:WORD_1 dst_unused:UNUSED_PRESERVE src0_sel:WORD_1
v_rcp_f16_sdwa v84, v84 dst_sel:WORD_1 dst_unused:UNUSED_PRESERVE src0_sel:WORD_1
v_rcp_f16_sdwa v85, v85 dst_sel:WORD_1 dst_unused:UNUSED_PRESERVE src0_sel:WORD_1
s_cmp_le_u32 s43, 9
s_nop 0
v_mfma_f32_16x16x32_f16 v[114:117], v[78:81], v[66:69], v[74:77]
v_mfma_f32_16x16x32_f16 v[114:117], v[82:85], v[70:73], v[114:117]
s_cbranch_scc1 L_drain
s_waitcnt lgkmcnt(0)
v_mfma_f32_16x16x32_bf16 v[78:81], v[2:5], v[94:97], v[34:37]
v_mfma_f32_16x16x32_bf16 v[78:81], v[6:9], v[98:101], v[78:81]
v_mfma_f32_16x16x32_bf16 v[82:85], v[10:13], v[94:97], v[38:41]
v_mfma_f32_16x16x32_bf16 v[82:85], v[14:17], v[98:101], v[82:85]
v_mfma_f32_16x16x32_bf16 v[86:89], v[18:21], v[94:97], v[42:45]
v_mfma_f32_16x16x32_bf16 v[86:89], v[22:25], v[98:101], v[86:89]
v_mfma_f32_16x16x32_bf16 v[90:93], v[26:29], v[94:97], v[46:49]
v_mfma_f32_16x16x32_bf16 v[90:93], v[30:33], v[98:101], v[90:93]
v_cvt_pk_bf16_f32 v114, v114, v115
v_cvt_pk_bf16_f32 v115, v116, v117
v_exp_f32 v78, v78
v_exp_f32 v79, v79
v_exp_f32 v80, v80
v_exp_f32 v81, v81
v_mfma_f32_4x4x4_16b_bf16 v[50:53], v[114:115], v[102:103], v[50:53]
v_exp_f32 v82, v82
v_exp_f32 v83, v83
v_exp_f32 v84, v84
v_exp_f32 v85, v85
v_mfma_f32_4x4x4_16b_bf16 v[54:57], v[114:115], v[104:105], v[54:57]
v_exp_f32 v86, v86
v_exp_f32 v87, v87
v_exp_f32 v88, v88
v_exp_f32 v89, v89
v_mfma_f32_4x4x4_16b_bf16 v[58:61], v[114:115], v[106:107], v[58:61]
v_exp_f32 v90, v90
v_exp_f32 v91, v91
v_exp_f32 v92, v92
v_exp_f32 v93, v93
v_mfma_f32_4x4x4_16b_bf16 v[62:65], v[114:115], v[108:109], v[62:65]
ds_read_b64_tr_b16 v[102:103], v120 offset:2048
ds_read_b64_tr_b16 v[104:105], v121 offset:2048
ds_read_b64_tr_b16 v[106:107], v122 offset:2048
ds_read_b64_tr_b16 v[108:109], v123 offset:2048
ds_read_b32 v116, v124 offset:4448
v_cvt_pk_f16_f32 v78, v78, v79
v_cvt_pk_f16_f32 v79, v80, v81
v_cvt_pk_f16_f32 v80, v82, v83
v_cvt_pk_f16_f32 v81, v84, v85
v_cvt_pk_f16_f32 v82, v86, v87
v_cvt_pk_f16_f32 v83, v88, v89
v_cvt_pk_f16_f32 v84, v90, v91
v_cvt_pk_f16_f32 v85, v92, v93
v_pk_add_f16 v78, v78, s69
v_pk_add_f16 v79, v79, s69
v_pk_add_f16 v80, v80, s69
v_pk_add_f16 v81, v81, s69
v_pk_add_f16 v82, v82, s69
v_pk_add_f16 v83, v83, s69
v_pk_add_f16 v84, v84, s69
v_pk_add_f16 v85, v85, s69
v_rcp_f16_sdwa v78, v78 dst_sel:WORD_0 dst_unused:UNUSED_PRESERVE src0_sel:WORD_0
v_rcp_f16_sdwa v79, v79 dst_sel:WORD_0 dst_unused:UNUSED_PRESERVE src0_sel:WORD_0
v_rcp_f16_sdwa v80, v80 dst_sel:WORD_0 dst_unused:UNUSED_PRESERVE src0_sel:WORD_0
v_rcp_f16_sdwa v81, v81 dst_sel:WORD_0 dst_unused:UNUSED_PRESERVE src0_sel:WORD_0
v_rcp_f16_sdwa v82, v82 dst_sel:WORD_0 dst_unused:UNUSED_PRESERVE src0_sel:WORD_0
v_rcp_f16_sdwa v83, v83 dst_sel:WORD_0 dst_unused:UNUSED_PRESERVE src0_sel:WORD_0
v_rcp_f16_sdwa v84, v84 dst_sel:WORD_0 dst_unused:UNUSED_PRESERVE src0_sel:WORD_0
v_rcp_f16_sdwa v85, v85 dst_sel:WORD_0 dst_unused:UNUSED_PRESERVE src0_sel:WORD_0
s_waitcnt lgkmcnt(0)
v_add_u32_sdwa v117, v126, v116 dst_sel:DWORD dst_unused:UNUSED_PAD src0_sel:DWORD src1_sel:WORD_1
v_add_u32_sdwa v116, v126, v116 dst_sel:DWORD dst_unused:UNUSED_PAD src0_sel:DWORD src1_sel:WORD_0
s_add_u32 m0, s41, 2048
s_nop 0
buffer_load_dwordx4 v116, s[20:23], 0 offen nt lds
s_add_u32 m0, s41, 3072
s_nop 0
buffer_load_dwordx4 v117, s[20:23], 0 offen nt lds
s_waitcnt vmcnt(2)
ds_read_b128 v[94:97], v118 offset:0
ds_read_b128 v[98:101], v119 offset:0
v_rcp_f16_sdwa v78, v78 dst_sel:WORD_1 dst_unused:UNUSED_PRESERVE src0_sel:WORD_1
v_rcp_f16_sdwa v79, v79 dst_sel:WORD_1 dst_unused:UNUSED_PRESERVE src0_sel:WORD_1
v_rcp_f16_sdwa v80, v80 dst_sel:WORD_1 dst_unused:UNUSED_PRESERVE src0_sel:WORD_1
v_rcp_f16_sdwa v81, v81 dst_sel:WORD_1 dst_unused:UNUSED_PRESERVE src0_sel:WORD_1
v_rcp_f16_sdwa v82, v82 dst_sel:WORD_1 dst_unused:UNUSED_PRESERVE src0_sel:WORD_1
v_rcp_f16_sdwa v83, v83 dst_sel:WORD_1 dst_unused:UNUSED_PRESERVE src0_sel:WORD_1
v_rcp_f16_sdwa v84, v84 dst_sel:WORD_1 dst_unused:UNUSED_PRESERVE src0_sel:WORD_1
v_rcp_f16_sdwa v85, v85 dst_sel:WORD_1 dst_unused:UNUSED_PRESERVE src0_sel:WORD_1
s_cmp_le_u32 s43, 10
s_nop 0
v_mfma_f32_16x16x32_f16 v[114:117], v[78:81], v[66:69], v[74:77]
v_mfma_f32_16x16x32_f16 v[114:117], v[82:85], v[70:73], v[114:117]
s_cbranch_scc1 L_drain
s_waitcnt lgkmcnt(0)
v_mfma_f32_16x16x32_bf16 v[78:81], v[2:5], v[94:97], v[34:37]
v_mfma_f32_16x16x32_bf16 v[78:81], v[6:9], v[98:101], v[78:81]
v_mfma_f32_16x16x32_bf16 v[82:85], v[10:13], v[94:97], v[38:41]
v_mfma_f32_16x16x32_bf16 v[82:85], v[14:17], v[98:101], v[82:85]
v_mfma_f32_16x16x32_bf16 v[86:89], v[18:21], v[94:97], v[42:45]
v_mfma_f32_16x16x32_bf16 v[86:89], v[22:25], v[98:101], v[86:89]
v_mfma_f32_16x16x32_bf16 v[90:93], v[26:29], v[94:97], v[46:49]
v_mfma_f32_16x16x32_bf16 v[90:93], v[30:33], v[98:101], v[90:93]
v_cvt_pk_bf16_f32 v114, v114, v115
v_cvt_pk_bf16_f32 v115, v116, v117
v_exp_f32 v78, v78
v_exp_f32 v79, v79
v_exp_f32 v80, v80
v_exp_f32 v81, v81
v_mfma_f32_4x4x4_16b_bf16 v[50:53], v[114:115], v[102:103], v[50:53]
v_exp_f32 v82, v82
v_exp_f32 v83, v83
v_exp_f32 v84, v84
v_exp_f32 v85, v85
v_mfma_f32_4x4x4_16b_bf16 v[54:57], v[114:115], v[104:105], v[54:57]
v_exp_f32 v86, v86
v_exp_f32 v87, v87
v_exp_f32 v88, v88
v_exp_f32 v89, v89
v_mfma_f32_4x4x4_16b_bf16 v[58:61], v[114:115], v[106:107], v[58:61]
v_exp_f32 v90, v90
v_exp_f32 v91, v91
v_exp_f32 v92, v92
v_exp_f32 v93, v93
v_mfma_f32_4x4x4_16b_bf16 v[62:65], v[114:115], v[108:109], v[62:65]
ds_read_b64_tr_b16 v[102:103], v120 offset:0
ds_read_b64_tr_b16 v[104:105], v121 offset:0
ds_read_b64_tr_b16 v[106:107], v122 offset:0
ds_read_b64_tr_b16 v[108:109], v123 offset:0
ds_read_b32 v116, v124 offset:4480
v_cvt_pk_f16_f32 v78, v78, v79
v_cvt_pk_f16_f32 v79, v80, v81
v_cvt_pk_f16_f32 v80, v82, v83
v_cvt_pk_f16_f32 v81, v84, v85
v_cvt_pk_f16_f32 v82, v86, v87
v_cvt_pk_f16_f32 v83, v88, v89
v_cvt_pk_f16_f32 v84, v90, v91
v_cvt_pk_f16_f32 v85, v92, v93
v_pk_add_f16 v78, v78, s69
v_pk_add_f16 v79, v79, s69
v_pk_add_f16 v80, v80, s69
v_pk_add_f16 v81, v81, s69
v_pk_add_f16 v82, v82, s69
v_pk_add_f16 v83, v83, s69
v_pk_add_f16 v84, v84, s69
v_pk_add_f16 v85, v85, s69
v_rcp_f16_sdwa v78, v78 dst_sel:WORD_0 dst_unused:UNUSED_PRESERVE src0_sel:WORD_0
v_rcp_f16_sdwa v79, v79 dst_sel:WORD_0 dst_unused:UNUSED_PRESERVE src0_sel:WORD_0
v_rcp_f16_sdwa v80, v80 dst_sel:WORD_0 dst_unused:UNUSED_PRESERVE src0_sel:WORD_0
v_rcp_f16_sdwa v81, v81 dst_sel:WORD_0 dst_unused:UNUSED_PRESERVE src0_sel:WORD_0
v_rcp_f16_sdwa v82, v82 dst_sel:WORD_0 dst_unused:UNUSED_PRESERVE src0_sel:WORD_0
v_rcp_f16_sdwa v83, v83 dst_sel:WORD_0 dst_unused:UNUSED_PRESERVE src0_sel:WORD_0
v_rcp_f16_sdwa v84, v84 dst_sel:WORD_0 dst_unused:UNUSED_PRESERVE src0_sel:WORD_0
v_rcp_f16_sdwa v85, v85 dst_sel:WORD_0 dst_unused:UNUSED_PRESERVE src0_sel:WORD_0
s_waitcnt lgkmcnt(0)
v_add_u32_sdwa v117, v126, v116 dst_sel:DWORD dst_unused:UNUSED_PAD src0_sel:DWORD src1_sel:WORD_1
v_add_u32_sdwa v116, v126, v116 dst_sel:DWORD dst_unused:UNUSED_PAD src0_sel:DWORD src1_sel:WORD_0
s_add_u32 m0, s41, 0
s_nop 0
buffer_load_dwordx4 v116, s[20:23], 0 offen nt lds
s_add_u32 m0, s41, 1024
s_nop 0
buffer_load_dwordx4 v117, s[20:23], 0 offen nt lds
s_waitcnt vmcnt(2)
ds_read_b128 v[94:97], v118 offset:2048
ds_read_b128 v[98:101], v119 offset:2048
v_rcp_f16_sdwa v78, v78 dst_sel:WORD_1 dst_unused:UNUSED_PRESERVE src0_sel:WORD_1
v_rcp_f16_sdwa v79, v79 dst_sel:WORD_1 dst_unused:UNUSED_PRESERVE src0_sel:WORD_1
v_rcp_f16_sdwa v80, v80 dst_sel:WORD_1 dst_unused:UNUSED_PRESERVE src0_sel:WORD_1
v_rcp_f16_sdwa v81, v81 dst_sel:WORD_1 dst_unused:UNUSED_PRESERVE src0_sel:WORD_1
v_rcp_f16_sdwa v82, v82 dst_sel:WORD_1 dst_unused:UNUSED_PRESERVE src0_sel:WORD_1
v_rcp_f16_sdwa v83, v83 dst_sel:WORD_1 dst_unused:UNUSED_PRESERVE src0_sel:WORD_1
v_rcp_f16_sdwa v84, v84 dst_sel:WORD_1 dst_unused:UNUSED_PRESERVE src0_sel:WORD_1
v_rcp_f16_sdwa v85, v85 dst_sel:WORD_1 dst_unused:UNUSED_PRESERVE src0_sel:WORD_1
s_cmp_le_u32 s43, 11
s_nop 0
v_mfma_f32_16x16x32_f16 v[114:117], v[78:81], v[66:69], v[74:77]
v_mfma_f32_16x16x32_f16 v[114:117], v[82:85], v[70:73], v[114:117]
s_cbranch_scc1 L_drain
s_waitcnt lgkmcnt(0)
v_mfma_f32_16x16x32_bf16 v[78:81], v[2:5], v[94:97], v[34:37]
v_mfma_f32_16x16x32_bf16 v[78:81], v[6:9], v[98:101], v[78:81]
v_mfma_f32_16x16x32_bf16 v[82:85], v[10:13], v[94:97], v[38:41]
v_mfma_f32_16x16x32_bf16 v[82:85], v[14:17], v[98:101], v[82:85]
v_mfma_f32_16x16x32_bf16 v[86:89], v[18:21], v[94:97], v[42:45]
v_mfma_f32_16x16x32_bf16 v[86:89], v[22:25], v[98:101], v[86:89]
v_mfma_f32_16x16x32_bf16 v[90:93], v[26:29], v[94:97], v[46:49]
v_mfma_f32_16x16x32_bf16 v[90:93], v[30:33], v[98:101], v[90:93]
v_cvt_pk_bf16_f32 v114, v114, v115
v_cvt_pk_bf16_f32 v115, v116, v117
v_exp_f32 v78, v78
v_exp_f32 v79, v79
v_exp_f32 v80, v80
v_exp_f32 v81, v81
v_mfma_f32_4x4x4_16b_bf16 v[50:53], v[114:115], v[102:103], v[50:53]
v_exp_f32 v82, v82
v_exp_f32 v83, v83
v_exp_f32 v84, v84
v_exp_f32 v85, v85
v_mfma_f32_4x4x4_16b_bf16 v[54:57], v[114:115], v[104:105], v[54:57]
v_exp_f32 v86, v86
v_exp_f32 v87, v87
v_exp_f32 v88, v88
v_exp_f32 v89, v89
v_mfma_f32_4x4x4_16b_bf16 v[58:61], v[114:115], v[106:107], v[58:61]
v_exp_f32 v90, v90
v_exp_f32 v91, v91
v_exp_f32 v92, v92
v_exp_f32 v93, v93
v_mfma_f32_4x4x4_16b_bf16 v[62:65], v[114:115], v[108:109], v[62:65]
ds_read_b64_tr_b16 v[102:103], v120 offset:2048
ds_read_b64_tr_b16 v[104:105], v121 offset:2048
ds_read_b64_tr_b16 v[106:107], v122 offset:2048
ds_read_b64_tr_b16 v[108:109], v123 offset:2048
v_cvt_pk_f16_f32 v78, v78, v79
v_cvt_pk_f16_f32 v79, v80, v81
v_cvt_pk_f16_f32 v80, v82, v83
v_cvt_pk_f16_f32 v81, v84, v85
v_cvt_pk_f16_f32 v82, v86, v87
v_cvt_pk_f16_f32 v83, v88, v89
v_cvt_pk_f16_f32 v84, v90, v91
v_cvt_pk_f16_f32 v85, v92, v93
v_pk_add_f16 v78, v78, s69
v_pk_add_f16 v79, v79, s69
v_pk_add_f16 v80, v80, s69
v_pk_add_f16 v81, v81, s69
v_pk_add_f16 v82, v82, s69
v_pk_add_f16 v83, v83, s69
v_pk_add_f16 v84, v84, s69
v_pk_add_f16 v85, v85, s69
v_rcp_f16_sdwa v78, v78 dst_sel:WORD_0 dst_unused:UNUSED_PRESERVE src0_sel:WORD_0
v_rcp_f16_sdwa v79, v79 dst_sel:WORD_0 dst_unused:UNUSED_PRESERVE src0_sel:WORD_0
v_rcp_f16_sdwa v80, v80 dst_sel:WORD_0 dst_unused:UNUSED_PRESERVE src0_sel:WORD_0
v_rcp_f16_sdwa v81, v81 dst_sel:WORD_0 dst_unused:UNUSED_PRESERVE src0_sel:WORD_0
v_rcp_f16_sdwa v82, v82 dst_sel:WORD_0 dst_unused:UNUSED_PRESERVE src0_sel:WORD_0
v_rcp_f16_sdwa v83, v83 dst_sel:WORD_0 dst_unused:UNUSED_PRESERVE src0_sel:WORD_0
v_rcp_f16_sdwa v84, v84 dst_sel:WORD_0 dst_unused:UNUSED_PRESERVE src0_sel:WORD_0
v_rcp_f16_sdwa v85, v85 dst_sel:WORD_0 dst_unused:UNUSED_PRESERVE src0_sel:WORD_0
s_waitcnt vmcnt(0)
ds_read_b128 v[94:97], v118 offset:0
ds_read_b128 v[98:101], v119 offset:0
v_rcp_f16_sdwa v78, v78 dst_sel:WORD_1 dst_unused:UNUSED_PRESERVE src0_sel:WORD_1
v_rcp_f16_sdwa v79, v79 dst_sel:WORD_1 dst_unused:UNUSED_PRESERVE src0_sel:WORD_1
v_rcp_f16_sdwa v80, v80 dst_sel:WORD_1 dst_unused:UNUSED_PRESERVE src0_sel:WORD_1
v_rcp_f16_sdwa v81, v81 dst_sel:WORD_1 dst_unused:UNUSED_PRESERVE src0_sel:WORD_1
v_rcp_f16_sdwa v82, v82 dst_sel:WORD_1 dst_unused:UNUSED_PRESERVE src0_sel:WORD_1
v_rcp_f16_sdwa v83, v83 dst_sel:WORD_1 dst_unused:UNUSED_PRESERVE src0_sel:WORD_1
v_rcp_f16_sdwa v84, v84 dst_sel:WORD_1 dst_unused:UNUSED_PRESERVE src0_sel:WORD_1
v_rcp_f16_sdwa v85, v85 dst_sel:WORD_1 dst_unused:UNUSED_PRESERVE src0_sel:WORD_1
s_cmp_le_u32 s43, 12
s_nop 0
v_mfma_f32_16x16x32_f16 v[114:117], v[78:81], v[66:69], v[74:77]
v_mfma_f32_16x16x32_f16 v[114:117], v[82:85], v[70:73], v[114:117]
s_cbranch_scc1 L_drain
s_waitcnt lgkmcnt(0)
v_mfma_f32_16x16x32_bf16 v[78:81], v[2:5], v[94:97], v[34:37]
v_mfma_f32_16x16x32_bf16 v[78:81], v[6:9], v[98:101], v[78:81]
v_mfma_f32_16x16x32_bf16 v[82:85], v[10:13], v[94:97], v[38:41]
v_mfma_f32_16x16x32_bf16 v[82:85], v[14:17], v[98:101], v[82:85]
v_mfma_f32_16x16x32_bf16 v[86:89], v[18:21], v[94:97], v[42:45]
v_mfma_f32_16x16x32_bf16 v[86:89], v[22:25], v[98:101], v[86:89]
v_mfma_f32_16x16x32_bf16 v[90:93], v[26:29], v[94:97], v[46:49]
v_mfma_f32_16x16x32_bf16 v[90:93], v[30:33], v[98:101], v[90:93]
v_cvt_pk_bf16_f32 v114, v114, v115
v_cvt_pk_bf16_f32 v115, v116, v117
v_exp_f32 v78, v78
v_exp_f32 v79, v79
v_exp_f32 v80, v80
v_exp_f32 v81, v81
v_mfma_f32_4x4x4_16b_bf16 v[50:53], v[114:115], v[102:103], v[50:53]
v_exp_f32 v82, v82
v_exp_f32 v83, v83
v_exp_f32 v84, v84
v_exp_f32 v85, v85
v_mfma_f32_4x4x4_16b_bf16 v[54:57], v[114:115], v[104:105], v[54:57]
v_exp_f32 v86, v86
v_exp_f32 v87, v87
v_exp_f32 v88, v88
v_exp_f32 v89, v89
v_mfma_f32_4x4x4_16b_bf16 v[58:61], v[114:115], v[106:107], v[58:61]
v_exp_f32 v90, v90
v_exp_f32 v91, v91
v_exp_f32 v92, v92
v_exp_f32 v93, v93
v_mfma_f32_4x4x4_16b_bf16 v[62:65], v[114:115], v[108:109], v[62:65]
ds_read_b64_tr_b16 v[102:103], v120 offset:0
ds_read_b64_tr_b16 v[104:105], v121 offset:0
ds_read_b64_tr_b16 v[106:107], v122 offset:0
ds_read_b64_tr_b16 v[108:109], v123 offset:0
v_cvt_pk_f16_f32 v78, v78, v79
v_cvt_pk_f16_f32 v79, v80, v81
v_cvt_pk_f16_f32 v80, v82, v83
v_cvt_pk_f16_f32 v81, v84, v85
v_cvt_pk_f16_f32 v82, v86, v87
v_cvt_pk_f16_f32 v83, v88, v89
v_cvt_pk_f16_f32 v84, v90, v91
v_cvt_pk_f16_f32 v85, v92, v93
v_pk_add_f16 v78, v78, s69
v_pk_add_f16 v79, v79, s69
v_pk_add_f16 v80, v80, s69
v_pk_add_f16 v81, v81, s69
v_pk_add_f16 v82, v82, s69
v_pk_add_f16 v83, v83, s69
v_pk_add_f16 v84, v84, s69
v_pk_add_f16 v85, v85, s69
v_rcp_f16_sdwa v78, v78 dst_sel:WORD_0 dst_unused:UNUSED_PRESERVE src0_sel:WORD_0
v_rcp_f16_sdwa v79, v79 dst_sel:WORD_0 dst_unused:UNUSED_PRESERVE src0_sel:WORD_0
v_rcp_f16_sdwa v80, v80 dst_sel:WORD_0 dst_unused:UNUSED_PRESERVE src0_sel:WORD_0
v_rcp_f16_sdwa v81, v81 dst_sel:WORD_0 dst_unused:UNUSED_PRESERVE src0_sel:WORD_0
v_rcp_f16_sdwa v82, v82 dst_sel:WORD_0 dst_unused:UNUSED_PRESERVE src0_sel:WORD_0
v_rcp_f16_sdwa v83, v83 dst_sel:WORD_0 dst_unused:UNUSED_PRESERVE src0_sel:WORD_0
v_rcp_f16_sdwa v84, v84 dst_sel:WORD_0 dst_unused:UNUSED_PRESERVE src0_sel:WORD_0
v_rcp_f16_sdwa v85, v85 dst_sel:WORD_0 dst_unused:UNUSED_PRESERVE src0_sel:WORD_0
v_rcp_f16_sdwa v78, v78 dst_sel:WORD_1 dst_unused:UNUSED_PRESERVE src0_sel:WORD_1
v_rcp_f16_sdwa v79, v79 dst_sel:WORD_1 dst_unused:UNUSED_PRESERVE src0_sel:WORD_1
v_rcp_f16_sdwa v80, v80 dst_sel:WORD_1 dst_unused:UNUSED_PRESERVE src0_sel:WORD_1
v_rcp_f16_sdwa v81, v81 dst_sel:WORD_1 dst_unused:UNUSED_PRESERVE src0_sel:WORD_1
v_rcp_f16_sdwa v82, v82 dst_sel:WORD_1 dst_unused:UNUSED_PRESERVE src0_sel:WORD_1
v_rcp_f16_sdwa v83, v83 dst_sel:WORD_1 dst_unused:UNUSED_PRESERVE src0_sel:WORD_1
v_rcp_f16_sdwa v84, v84 dst_sel:WORD_1 dst_unused:UNUSED_PRESERVE src0_sel:WORD_1
v_rcp_f16_sdwa v85, v85 dst_sel:WORD_1 dst_unused:UNUSED_PRESERVE src0_sel:WORD_1
s_waitcnt lgkmcnt(0)
s_nop 0
v_mfma_f32_16x16x32_f16 v[114:117], v[78:81], v[66:69], v[74:77]
v_mfma_f32_16x16x32_f16 v[114:117], v[82:85], v[70:73], v[114:117]
L_drain:
s_waitcnt lgkmcnt(0)
s_nop 6
v_cvt_pk_bf16_f32 v114, v114, v115
v_cvt_pk_bf16_f32 v115, v116, v117
s_nop 1
v_mfma_f32_4x4x4_16b_bf16 v[50:53], v[114:115], v[102:103], v[50:53]
v_mfma_f32_4x4x4_16b_bf16 v[54:57], v[114:115], v[104:105], v[54:57]
v_mfma_f32_4x4x4_16b_bf16 v[58:61], v[114:115], v[106:107], v[58:61]
v_mfma_f32_4x4x4_16b_bf16 v[62:65], v[114:115], v[108:109], v[62:65]
L_end:
v_lshlrev_b32 v127, 1, v0
s_nop 3
v_permlane32_swap_b32 v50, v58
v_permlane32_swap_b32 v54, v62
s_nop 0
v_add_f32 v50, v50, v58
v_add_f32 v54, v54, v62
s_nop 1
v_permlane16_swap_b32 v50, v54
s_nop 0
v_add_f32 v50, v50, v54
s_nop 0
v_mul_f32 v50, s66, v50
v_cvt_pk_bf16_f32 v50, v50, v50
L_store:
s_waitcnt vmcnt(0)
buffer_store_short v50, v127, s[36:39], 0 offen
s_endpgm
L_drain0:
s_waitcnt lgkmcnt(0)
s_nop 6
v_cvt_pk_bf16_f32 v114, v114, v115
v_cvt_pk_bf16_f32 v115, v116, v117
s_nop 1
v_mfma_f32_4x4x4_16b_bf16 v[50:53], v[114:115], v[102:103], 0
v_mfma_f32_4x4x4_16b_bf16 v[54:57], v[114:115], v[104:105], 0
v_mfma_f32_4x4x4_16b_bf16 v[58:61], v[114:115], v[106:107], 0
v_mfma_f32_4x4x4_16b_bf16 v[62:65], v[114:115], v[108:109], 0
s_branch L_end
L_general:
s_setprio 2
s_nop 1
v_exp_f32 v78, v78
v_exp_f32 v79, v79
v_exp_f32 v80, v80
v_exp_f32 v81, v81
v_exp_f32 v82, v82
v_exp_f32 v83, v83
v_exp_f32 v84, v84
v_exp_f32 v85, v85
v_exp_f32 v86, v86
v_exp_f32 v87, v87
v_exp_f32 v88, v88
v_exp_f32 v89, v89
v_exp_f32 v90, v90
v_exp_f32 v91, v91
v_exp_f32 v92, v92
v_exp_f32 v93, v93
ds_read_b64_tr_b16 v[102:103], v120 offset:0
ds_read_b64_tr_b16 v[104:105], v121 offset:0
ds_read_b64_tr_b16 v[106:107], v122 offset:0
ds_read_b64_tr_b16 v[108:109], v123 offset:0
ds_read_b128 v[110:113], v125 offset:4608
ds_read_b32 v116, v124 offset:4160
v_cvt_pk_f16_f32 v78, v78, v79
v_cvt_pk_f16_f32 v79, v80, v81
v_cvt_pk_f16_f32 v80, v82, v83
v_cvt_pk_f16_f32 v81, v84, v85
v_cvt_pk_f16_f32 v82, v86, v87
v_cvt_pk_f16_f32 v83, v88, v89
v_cvt_pk_f16_f32 v84, v90, v91
v_cvt_pk_f16_f32 v85, v92, v93
v_pk_add_f16 v78, v78, s69
v_pk_add_f16 v79, v79, s69
v_pk_add_f16 v80, v80, s69
v_pk_add_f16 v81, v81, s69
v_pk_add_f16 v82, v82, s69
v_pk_add_f16 v83, v83, s69
v_pk_add_f16 v84, v84, s69
v_pk_add_f16 v85, v85, s69
v_rcp_f16_sdwa v78, v78 dst_sel:WORD_0 dst_unused:UNUSED_PRESERVE src0_sel:WORD_0
v_rcp_f16_sdwa v79, v79 dst_sel:WORD_0 dst_unused:UNUSED_PRESERVE src0_sel:WORD_0
v_rcp_f16_sdwa v80, v80 dst_sel:WORD_0 dst_unused:UNUSED_PRESERVE src0_sel:WORD_0
v_rcp_f16_sdwa v81, v81 dst_sel:WORD_0 dst_unused:UNUSED_PRESERVE src0_sel:WORD_0
v_rcp_f16_sdwa v82, v82 dst_sel:WORD_0 dst_unused:UNUSED_PRESERVE src0_sel:WORD_0
v_rcp_f16_sdwa v83, v83 dst_sel:WORD_0 dst_unused:UNUSED_PRESERVE src0_sel:WORD_0
v_rcp_f16_sdwa v84, v84 dst_sel:WORD_0 dst_unused:UNUSED_PRESERVE src0_sel:WORD_0
v_rcp_f16_sdwa v85, v85 dst_sel:WORD_0 dst_unused:UNUSED_PRESERVE src0_sel:WORD_0
s_waitcnt lgkmcnt(0)
v_add_u32_sdwa v117, v126, v116 dst_sel:DWORD dst_unused:UNUSED_PAD src0_sel:DWORD src1_sel:WORD_1
v_add_u32_sdwa v116, v126, v116 dst_sel:DWORD dst_unused:UNUSED_PAD src0_sel:DWORD src1_sel:WORD_0
s_add_u32 m0, s41, 0
s_nop 0
buffer_load_dwordx4 v116, s[20:23], 0 offen nt lds
s_add_u32 m0, s41, 1024
s_nop 0
buffer_load_dwordx4 v117, s[20:23], 0 offen nt lds
s_waitcnt vmcnt(2)
ds_read_b128 v[94:97], v118 offset:2048
ds_read_b128 v[98:101], v119 offset:2048
v_rcp_f16_sdwa v78, v78 dst_sel:WORD_1 dst_unused:UNUSED_PRESERVE src0_sel:WORD_1
v_rcp_f16_sdwa v79, v79 dst_sel:WORD_1 dst_unused:UNUSED_PRESERVE src0_sel:WORD_1
v_rcp_f16_sdwa v80, v80 dst_sel:WORD_1 dst_unused:UNUSED_PRESERVE src0_sel:WORD_1
v_rcp_f16_sdwa v81, v81 dst_sel:WORD_1 dst_unused:UNUSED_PRESERVE src0_sel:WORD_1
v_rcp_f16_sdwa v82, v82 dst_sel:WORD_1 dst_unused:UNUSED_PRESERVE src0_sel:WORD_1
v_rcp_f16_sdwa v83, v83 dst_sel:WORD_1 dst_unused:UNUSED_PRESERVE src0_sel:WORD_1
v_rcp_f16_sdwa v84, v84 dst_sel:WORD_1 dst_unused:UNUSED_PRESERVE src0_sel:WORD_1
v_rcp_f16_sdwa v85, v85 dst_sel:WORD_1 dst_unused:UNUSED_PRESERVE src0_sel:WORD_1
s_cmp_le_u32 s43, 1
s_nop 0
v_mfma_f32_16x16x32_f16 v[114:117], v[78:81], v[66:69], v[74:77]
v_mfma_f32_16x16x32_f16 v[114:117], v[82:85], v[70:73], v[114:117]
s_cbranch_scc1 L_drain0_g
s_waitcnt lgkmcnt(0)
v_mfma_f32_16x16x32_bf16 v[78:81], v[2:5], v[94:97], v[34:37]
v_mfma_f32_16x16x32_bf16 v[78:81], v[6:9], v[98:101], v[78:81]
v_mfma_f32_16x16x32_bf16 v[82:85], v[10:13], v[94:97], v[38:41]
v_mfma_f32_16x16x32_bf16 v[82:85], v[14:17], v[98:101], v[82:85]
v_mfma_f32_16x16x32_bf16 v[86:89], v[18:21], v[94:97], v[42:45]
v_mfma_f32_16x16x32_bf16 v[86:89], v[22:25], v[98:101], v[86:89]
v_mfma_f32_16x16x32_bf16 v[90:93], v[26:29], v[94:97], v[46:49]
v_mfma_f32_16x16x32_bf16 v[90:93], v[30:33], v[98:101], v[90:93]
s_setprio 1
v_mul_f32 v114, v114, v110
v_mul_f32 v115, v115, v111
v_mul_f32 v116, v116, v112
v_mul_f32 v117, v117, v113
v_cvt_pk_bf16_f32 v114, v114, v115
v_cvt_pk_bf16_f32 v115, v116, v117
v_exp_f32 v78, v78
v_exp_f32 v79, v79
v_exp_f32 v80, v80
v_exp_f32 v81, v81
v_mfma_f32_4x4x4_16b_bf16 v[50:53], v[114:115], v[102:103], 0
v_exp_f32 v82, v82
v_exp_f32 v83, v83
v_exp_f32 v84, v84
v_exp_f32 v85, v85
v_mfma_f32_4x4x4_16b_bf16 v[54:57], v[114:115], v[104:105], 0
v_exp_f32 v86, v86
v_exp_f32 v87, v87
v_exp_f32 v88, v88
v_exp_f32 v89, v89
v_mfma_f32_4x4x4_16b_bf16 v[58:61], v[114:115], v[106:107], 0
v_exp_f32 v90, v90
v_exp_f32 v91, v91
v_exp_f32 v92, v92
v_exp_f32 v93, v93
v_mfma_f32_4x4x4_16b_bf16 v[62:65], v[114:115], v[108:109], 0
ds_read_b64_tr_b16 v[102:103], v120 offset:2048
ds_read_b64_tr_b16 v[104:105], v121 offset:2048
ds_read_b64_tr_b16 v[106:107], v122 offset:2048
ds_read_b64_tr_b16 v[108:109], v123 offset:2048
ds_read_b128 v[110:113], v125 offset:4672
ds_read_b32 v116, v124 offset:4192
v_cvt_pk_f16_f32 v78, v78, v79
v_cvt_pk_f16_f32 v79, v80, v81
v_cvt_pk_f16_f32 v80, v82, v83
v_cvt_pk_f16_f32 v81, v84, v85
v_cvt_pk_f16_f32 v82, v86, v87
v_cvt_pk_f16_f32 v83, v88, v89
v_cvt_pk_f16_f32 v84, v90, v91
v_cvt_pk_f16_f32 v85, v92, v93
v_pk_add_f16 v78, v78, s69
v_pk_add_f16 v79, v79, s69
v_pk_add_f16 v80, v80, s69
v_pk_add_f16 v81, v81, s69
v_pk_add_f16 v82, v82, s69
v_pk_add_f16 v83, v83, s69
v_pk_add_f16 v84, v84, s69
v_pk_add_f16 v85, v85, s69
v_rcp_f16_sdwa v78, v78 dst_sel:WORD_0 dst_unused:UNUSED_PRESERVE src0_sel:WORD_0
v_rcp_f16_sdwa v79, v79 dst_sel:WORD_0 dst_unused:UNUSED_PRESERVE src0_sel:WORD_0
v_rcp_f16_sdwa v80, v80 dst_sel:WORD_0 dst_unused:UNUSED_PRESERVE src0_sel:WORD_0
v_rcp_f16_sdwa v81, v81 dst_sel:WORD_0 dst_unused:UNUSED_PRESERVE src0_sel:WORD_0
v_rcp_f16_sdwa v82, v82 dst_sel:WORD_0 dst_unused:UNUSED_PRESERVE src0_sel:WORD_0
v_rcp_f16_sdwa v83, v83 dst_sel:WORD_0 dst_unused:UNUSED_PRESERVE src0_sel:WORD_0
v_rcp_f16_sdwa v84, v84 dst_sel:WORD_0 dst_unused:UNUSED_PRESERVE src0_sel:WORD_0
v_rcp_f16_sdwa v85, v85 dst_sel:WORD_0 dst_unused:UNUSED_PRESERVE src0_sel:WORD_0
s_waitcnt lgkmcnt(0)
v_add_u32_sdwa v117, v126, v116 dst_sel:DWORD dst_unused:UNUSED_PAD src0_sel:DWORD src1_sel:WORD_1
v_add_u32_sdwa v116, v126, v116 dst_sel:DWORD dst_unused:UNUSED_PAD src0_sel:DWORD src1_sel:WORD_0
s_add_u32 m0, s41, 2048
s_nop 0
buffer_load_dwordx4 v116, s[20:23], 0 offen nt lds
s_add_u32 m0, s41, 3072
s_nop 0
buffer_load_dwordx4 v117, s[20:23], 0 offen nt lds
s_waitcnt vmcnt(2)
ds_read_b128 v[94:97], v118 offset:0
ds_read_b128 v[98:101], v119 offset:0
v_rcp_f16_sdwa v78, v78 dst_sel:WORD_1 dst_unused:UNUSED_PRESERVE src0_sel:WORD_1
v_rcp_f16_sdwa v79, v79 dst_sel:WORD_1 dst_unused:UNUSED_PRESERVE src0_sel:WORD_1
v_rcp_f16_sdwa v80, v80 dst_sel:WORD_1 dst_unused:UNUSED_PRESERVE src0_sel:WORD_1
v_rcp_f16_sdwa v81, v81 dst_sel:WORD_1 dst_unused:UNUSED_PRESERVE src0_sel:WORD_1
v_rcp_f16_sdwa v82, v82 dst_sel:WORD_1 dst_unused:UNUSED_PRESERVE src0_sel:WORD_1
v_rcp_f16_sdwa v83, v83 dst_sel:WORD_1 dst_unused:UNUSED_PRESERVE src0_sel:WORD_1
v_rcp_f16_sdwa v84, v84 dst_sel:WORD_1 dst_unused:UNUSED_PRESERVE src0_sel:WORD_1
v_rcp_f16_sdwa v85, v85 dst_sel:WORD_1 dst_unused:UNUSED_PRESERVE src0_sel:WORD_1
s_cmp_le_u32 s43, 2
s_nop 0
v_mfma_f32_16x16x32_f16 v[114:117], v[78:81], v[66:69], v[74:77]
v_mfma_f32_16x16x32_f16 v[114:117], v[82:85], v[70:73], v[114:117]
s_cbranch_scc1 L_drain_g
s_waitcnt lgkmcnt(0)
v_mfma_f32_16x16x32_bf16 v[78:81], v[2:5], v[94:97], v[34:37]
v_mfma_f32_16x16x32_bf16 v[78:81], v[6:9], v[98:101], v[78:81]
v_mfma_f32_16x16x32_bf16 v[82:85], v[10:13], v[94:97], v[38:41]
v_mfma_f32_16x16x32_bf16 v[82:85], v[14:17], v[98:101], v[82:85]
v_mfma_f32_16x16x32_bf16 v[86:89], v[18:21], v[94:97], v[42:45]
v_mfma_f32_16x16x32_bf16 v[86:89], v[22:25], v[98:101], v[86:89]
v_mfma_f32_16x16x32_bf16 v[90:93], v[26:29], v[94:97], v[46:49]
v_mfma_f32_16x16x32_bf16 v[90:93], v[30:33], v[98:101], v[90:93]
s_setprio 2
v_mul_f32 v114, v114, v110
v_mul_f32 v115, v115, v111
v_mul_f32 v116, v116, v112
v_mul_f32 v117, v117, v113
v_cvt_pk_bf16_f32 v114, v114, v115
v_cvt_pk_bf16_f32 v115, v116, v117
v_exp_f32 v78, v78
v_exp_f32 v79, v79
v_exp_f32 v80, v80
v_exp_f32 v81, v81
v_mfma_f32_4x4x4_16b_bf16 v[50:53], v[114:115], v[102:103], v[50:53]
v_exp_f32 v82, v82
v_exp_f32 v83, v83
v_exp_f32 v84, v84
v_exp_f32 v85, v85
v_mfma_f32_4x4x4_16b_bf16 v[54:57], v[114:115], v[104:105], v[54:57]
v_exp_f32 v86, v86
v_exp_f32 v87, v87
v_exp_f32 v88, v88
v_exp_f32 v89, v89
v_mfma_f32_4x4x4_16b_bf16 v[58:61], v[114:115], v[106:107], v[58:61]
v_exp_f32 v90, v90
v_exp_f32 v91, v91
v_exp_f32 v92, v92
v_exp_f32 v93, v93
v_mfma_f32_4x4x4_16b_bf16 v[62:65], v[114:115], v[108:109], v[62:65]
ds_read_b64_tr_b16 v[102:103], v120 offset:0
ds_read_b64_tr_b16 v[104:105], v121 offset:0
ds_read_b64_tr_b16 v[106:107], v122 offset:0
ds_read_b64_tr_b16 v[108:109], v123 offset:0
ds_read_b128 v[110:113], v125 offset:4736
ds_read_b32 v116, v124 offset:4224
v_cvt_pk_f16_f32 v78, v78, v79
v_cvt_pk_f16_f32 v79, v80, v81
v_cvt_pk_f16_f32 v80, v82, v83
v_cvt_pk_f16_f32 v81, v84, v85
v_cvt_pk_f16_f32 v82, v86, v87
v_cvt_pk_f16_f32 v83, v88, v89
v_cvt_pk_f16_f32 v84, v90, v91
v_cvt_pk_f16_f32 v85, v92, v93
v_pk_add_f16 v78, v78, s69
v_pk_add_f16 v79, v79, s69
v_pk_add_f16 v80, v80, s69
v_pk_add_f16 v81, v81, s69
v_pk_add_f16 v82, v82, s69
v_pk_add_f16 v83, v83, s69
v_pk_add_f16 v84, v84, s69
v_pk_add_f16 v85, v85, s69
v_rcp_f16_sdwa v78, v78 dst_sel:WORD_0 dst_unused:UNUSED_PRESERVE src0_sel:WORD_0
v_rcp_f16_sdwa v79, v79 dst_sel:WORD_0 dst_unused:UNUSED_PRESERVE src0_sel:WORD_0
v_rcp_f16_sdwa v80, v80 dst_sel:WORD_0 dst_unused:UNUSED_PRESERVE src0_sel:WORD_0
v_rcp_f16_sdwa v81, v81 dst_sel:WORD_0 dst_unused:UNUSED_PRESERVE src0_sel:WORD_0
v_rcp_f16_sdwa v82, v82 dst_sel:WORD_0 dst_unused:UNUSED_PRESERVE src0_sel:WORD_0
v_rcp_f16_sdwa v83, v83 dst_sel:WORD_0 dst_unused:UNUSED_PRESERVE src0_sel:WORD_0
v_rcp_f16_sdwa v84, v84 dst_sel:WORD_0 dst_unused:UNUSED_PRESERVE src0_sel:WORD_0
v_rcp_f16_sdwa v85, v85 dst_sel:WORD_0 dst_unused:UNUSED_PRESERVE src0_sel:WORD_0
s_waitcnt lgkmcnt(0)
v_add_u32_sdwa v117, v126, v116 dst_sel:DWORD dst_unused:UNUSED_PAD src0_sel:DWORD src1_sel:WORD_1
v_add_u32_sdwa v116, v126, v116 dst_sel:DWORD dst_unused:UNUSED_PAD src0_sel:DWORD src1_sel:WORD_0
s_add_u32 m0, s41, 0
s_nop 0
buffer_load_dwordx4 v116, s[20:23], 0 offen nt lds
s_add_u32 m0, s41, 1024
s_nop 0
buffer_load_dwordx4 v117, s[20:23], 0 offen nt lds
s_waitcnt vmcnt(2)
ds_read_b128 v[94:97], v118 offset:2048
ds_read_b128 v[98:101], v119 offset:2048
v_rcp_f16_sdwa v78, v78 dst_sel:WORD_1 dst_unused:UNUSED_PRESERVE src0_sel:WORD_1
v_rcp_f16_sdwa v79, v79 dst_sel:WORD_1 dst_unused:UNUSED_PRESERVE src0_sel:WORD_1
v_rcp_f16_sdwa v80, v80 dst_sel:WORD_1 dst_unused:UNUSED_PRESERVE src0_sel:WORD_1
v_rcp_f16_sdwa v81, v81 dst_sel:WORD_1 dst_unused:UNUSED_PRESERVE src0_sel:WORD_1
v_rcp_f16_sdwa v82, v82 dst_sel:WORD_1 dst_unused:UNUSED_PRESERVE src0_sel:WORD_1
v_rcp_f16_sdwa v83, v83 dst_sel:WORD_1 dst_unused:UNUSED_PRESERVE src0_sel:WORD_1
v_rcp_f16_sdwa v84, v84 dst_sel:WORD_1 dst_unused:UNUSED_PRESERVE src0_sel:WORD_1
v_rcp_f16_sdwa v85, v85 dst_sel:WORD_1 dst_unused:UNUSED_PRESERVE src0_sel:WORD_1
s_cmp_le_u32 s43, 3
s_nop 0
v_mfma_f32_16x16x32_f16 v[114:117], v[78:81], v[66:69], v[74:77]
v_mfma_f32_16x16x32_f16 v[114:117], v[82:85], v[70:73], v[114:117]
s_cbranch_scc1 L_drain_g
s_waitcnt lgkmcnt(0)
v_mfma_f32_16x16x32_bf16 v[78:81], v[2:5], v[94:97], v[34:37]
v_mfma_f32_16x16x32_bf16 v[78:81], v[6:9], v[98:101], v[78:81]
v_mfma_f32_16x16x32_bf16 v[82:85], v[10:13], v[94:97], v[38:41]
v_mfma_f32_16x16x32_bf16 v[82:85], v[14:17], v[98:101], v[82:85]
v_mfma_f32_16x16x32_bf16 v[86:89], v[18:21], v[94:97], v[42:45]
v_mfma_f32_16x16x32_bf16 v[86:89], v[22:25], v[98:101], v[86:89]
v_mfma_f32_16x16x32_bf16 v[90:93], v[26:29], v[94:97], v[46:49]
v_mfma_f32_16x16x32_bf16 v[90:93], v[30:33], v[98:101], v[90:93]
s_setprio 1
v_mul_f32 v114, v114, v110
v_mul_f32 v115, v115, v111
v_mul_f32 v116, v116, v112
v_mul_f32 v117, v117, v113
v_cvt_pk_bf16_f32 v114, v114, v115
v_cvt_pk_bf16_f32 v115, v116, v117
v_exp_f32 v78, v78
v_exp_f32 v79, v79
v_exp_f32 v80, v80
v_exp_f32 v81, v81
v_mfma_f32_4x4x4_16b_bf16 v[50:53], v[114:115], v[102:103], v[50:53]
v_exp_f32 v82, v82
v_exp_f32 v83, v83
v_exp_f32 v84, v84
v_exp_f32 v85, v85
v_mfma_f32_4x4x4_16b_bf16 v[54:57], v[114:115], v[104:105], v[54:57]
v_exp_f32 v86, v86
v_exp_f32 v87, v87
v_exp_f32 v88, v88
v_exp_f32 v89, v89
v_mfma_f32_4x4x4_16b_bf16 v[58:61], v[114:115], v[106:107], v[58:61]
v_exp_f32 v90, v90
v_exp_f32 v91, v91
v_exp_f32 v92, v92
v_exp_f32 v93, v93
v_mfma_f32_4x4x4_16b_bf16 v[62:65], v[114:115], v[108:109], v[62:65]
ds_read_b64_tr_b16 v[102:103], v120 offset:2048
ds_read_b64_tr_b16 v[104:105], v121 offset:2048
ds_read_b64_tr_b16 v[106:107], v122 offset:2048
ds_read_b64_tr_b16 v[108:109], v123 offset:2048
ds_read_b128 v[110:113], v125 offset:4800
ds_read_b32 v116, v124 offset:4256
v_cvt_pk_f16_f32 v78, v78, v79
v_cvt_pk_f16_f32 v79, v80, v81
v_cvt_pk_f16_f32 v80, v82, v83
v_cvt_pk_f16_f32 v81, v84, v85
v_cvt_pk_f16_f32 v82, v86, v87
v_cvt_pk_f16_f32 v83, v88, v89
v_cvt_pk_f16_f32 v84, v90, v91
v_cvt_pk_f16_f32 v85, v92, v93
v_pk_add_f16 v78, v78, s69
v_pk_add_f16 v79, v79, s69
v_pk_add_f16 v80, v80, s69
v_pk_add_f16 v81, v81, s69
v_pk_add_f16 v82, v82, s69
v_pk_add_f16 v83, v83, s69
v_pk_add_f16 v84, v84, s69
v_pk_add_f16 v85, v85, s69
v_rcp_f16_sdwa v78, v78 dst_sel:WORD_0 dst_unused:UNUSED_PRESERVE src0_sel:WORD_0
v_rcp_f16_sdwa v79, v79 dst_sel:WORD_0 dst_unused:UNUSED_PRESERVE src0_sel:WORD_0
v_rcp_f16_sdwa v80, v80 dst_sel:WORD_0 dst_unused:UNUSED_PRESERVE src0_sel:WORD_0
v_rcp_f16_sdwa v81, v81 dst_sel:WORD_0 dst_unused:UNUSED_PRESERVE src0_sel:WORD_0
v_rcp_f16_sdwa v82, v82 dst_sel:WORD_0 dst_unused:UNUSED_PRESERVE src0_sel:WORD_0
v_rcp_f16_sdwa v83, v83 dst_sel:WORD_0 dst_unused:UNUSED_PRESERVE src0_sel:WORD_0
v_rcp_f16_sdwa v84, v84 dst_sel:WORD_0 dst_unused:UNUSED_PRESERVE src0_sel:WORD_0
v_rcp_f16_sdwa v85, v85 dst_sel:WORD_0 dst_unused:UNUSED_PRESERVE src0_sel:WORD_0
s_waitcnt lgkmcnt(0)
v_add_u32_sdwa v117, v126, v116 dst_sel:DWORD dst_unused:UNUSED_PAD src0_sel:DWORD src1_sel:WORD_1
v_add_u32_sdwa v116, v126, v116 dst_sel:DWORD dst_unused:UNUSED_PAD src0_sel:DWORD src1_sel:WORD_0
s_add_u32 m0, s41, 2048
s_nop 0
buffer_load_dwordx4 v116, s[20:23], 0 offen nt lds
s_add_u32 m0, s41, 3072
s_nop 0
buffer_load_dwordx4 v117, s[20:23], 0 offen nt lds
s_waitcnt vmcnt(2)
ds_read_b128 v[94:97], v118 offset:0
ds_read_b128 v[98:101], v119 offset:0
v_rcp_f16_sdwa v78, v78 dst_sel:WORD_1 dst_unused:UNUSED_PRESERVE src0_sel:WORD_1
v_rcp_f16_sdwa v79, v79 dst_sel:WORD_1 dst_unused:UNUSED_PRESERVE src0_sel:WORD_1
v_rcp_f16_sdwa v80, v80 dst_sel:WORD_1 dst_unused:UNUSED_PRESERVE src0_sel:WORD_1
v_rcp_f16_sdwa v81, v81 dst_sel:WORD_1 dst_unused:UNUSED_PRESERVE src0_sel:WORD_1
v_rcp_f16_sdwa v82, v82 dst_sel:WORD_1 dst_unused:UNUSED_PRESERVE src0_sel:WORD_1
v_rcp_f16_sdwa v83, v83 dst_sel:WORD_1 dst_unused:UNUSED_PRESERVE src0_sel:WORD_1
v_rcp_f16_sdwa v84, v84 dst_sel:WORD_1 dst_unused:UNUSED_PRESERVE src0_sel:WORD_1
v_rcp_f16_sdwa v85, v85 dst_sel:WORD_1 dst_unused:UNUSED_PRESERVE src0_sel:WORD_1
s_cmp_le_u32 s43, 4
s_nop 0
v_mfma_f32_16x16x32_f16 v[114:117], v[78:81], v[66:69], v[74:77]
v_mfma_f32_16x16x32_f16 v[114:117], v[82:85], v[70:73], v[114:117]
s_cbranch_scc1 L_drain_g
s_waitcnt lgkmcnt(0)
v_mfma_f32_16x16x32_bf16 v[78:81], v[2:5], v[94:97], v[34:37]
v_mfma_f32_16x16x32_bf16 v[78:81], v[6:9], v[98:101], v[78:81]
v_mfma_f32_16x16x32_bf16 v[82:85], v[10:13], v[94:97], v[38:41]
v_mfma_f32_16x16x32_bf16 v[82:85], v[14:17], v[98:101], v[82:85]
v_mfma_f32_16x16x32_bf16 v[86:89], v[18:21], v[94:97], v[42:45]
v_mfma_f32_16x16x32_bf16 v[86:89], v[22:25], v[98:101], v[86:89]
v_mfma_f32_16x16x32_bf16 v[90:93], v[26:29], v[94:97], v[46:49]
v_mfma_f32_16x16x32_bf16 v[90:93], v[30:33], v[98:101], v[90:93]
s_setprio 2
v_mul_f32 v114, v114, v110
v_mul_f32 v115, v115, v111
v_mul_f32 v116, v116, v112
v_mul_f32 v117, v117, v113
v_cvt_pk_bf16_f32 v114, v114, v115
v_cvt_pk_bf16_f32 v115, v116, v117
v_exp_f32 v78, v78
v_exp_f32 v79, v79
v_exp_f32 v80, v80
v_exp_f32 v81, v81
v_mfma_f32_4x4x4_16b_bf16 v[50:53], v[114:115], v[102:103], v[50:53]
v_exp_f32 v82, v82
v_exp_f32 v83, v83
v_exp_f32 v84, v84
v_exp_f32 v85, v85
v_mfma_f32_4x4x4_16b_bf16 v[54:57], v[114:115], v[104:105], v[54:57]
v_exp_f32 v86, v86
v_exp_f32 v87, v87
v_exp_f32 v88, v88
v_exp_f32 v89, v89
v_mfma_f32_4x4x4_16b_bf16 v[58:61], v[114:115], v[106:107], v[58:61]
v_exp_f32 v90, v90
v_exp_f32 v91, v91
v_exp_f32 v92, v92
v_exp_f32 v93, v93
v_mfma_f32_4x4x4_16b_bf16 v[62:65], v[114:115], v[108:109], v[62:65]
ds_read_b64_tr_b16 v[102:103], v120 offset:0
ds_read_b64_tr_b16 v[104:105], v121 offset:0
ds_read_b64_tr_b16 v[106:107], v122 offset:0
ds_read_b64_tr_b16 v[108:109], v123 offset:0
ds_read_b128 v[110:113], v125 offset:4864
ds_read_b32 v116, v124 offset:4288
v_cvt_pk_f16_f32 v78, v78, v79
v_cvt_pk_f16_f32 v79, v80, v81
v_cvt_pk_f16_f32 v80, v82, v83
v_cvt_pk_f16_f32 v81, v84, v85
v_cvt_pk_f16_f32 v82, v86, v87
v_cvt_pk_f16_f32 v83, v88, v89
v_cvt_pk_f16_f32 v84, v90, v91
v_cvt_pk_f16_f32 v85, v92, v93
v_pk_add_f16 v78, v78, s69
v_pk_add_f16 v79, v79, s69
v_pk_add_f16 v80, v80, s69
v_pk_add_f16 v81, v81, s69
v_pk_add_f16 v82, v82, s69
v_pk_add_f16 v83, v83, s69
v_pk_add_f16 v84, v84, s69
v_pk_add_f16 v85, v85, s69
v_rcp_f16_sdwa v78, v78 dst_sel:WORD_0 dst_unused:UNUSED_PRESERVE src0_sel:WORD_0
v_rcp_f16_sdwa v79, v79 dst_sel:WORD_0 dst_unused:UNUSED_PRESERVE src0_sel:WORD_0
v_rcp_f16_sdwa v80, v80 dst_sel:WORD_0 dst_unused:UNUSED_PRESERVE src0_sel:WORD_0
v_rcp_f16_sdwa v81, v81 dst_sel:WORD_0 dst_unused:UNUSED_PRESERVE src0_sel:WORD_0
v_rcp_f16_sdwa v82, v82 dst_sel:WORD_0 dst_unused:UNUSED_PRESERVE src0_sel:WORD_0
v_rcp_f16_sdwa v83, v83 dst_sel:WORD_0 dst_unused:UNUSED_PRESERVE src0_sel:WORD_0
v_rcp_f16_sdwa v84, v84 dst_sel:WORD_0 dst_unused:UNUSED_PRESERVE src0_sel:WORD_0
v_rcp_f16_sdwa v85, v85 dst_sel:WORD_0 dst_unused:UNUSED_PRESERVE src0_sel:WORD_0
s_waitcnt lgkmcnt(0)
v_add_u32_sdwa v117, v126, v116 dst_sel:DWORD dst_unused:UNUSED_PAD src0_sel:DWORD src1_sel:WORD_1
v_add_u32_sdwa v116, v126, v116 dst_sel:DWORD dst_unused:UNUSED_PAD src0_sel:DWORD src1_sel:WORD_0
s_add_u32 m0, s41, 0
s_nop 0
buffer_load_dwordx4 v116, s[20:23], 0 offen nt lds
s_add_u32 m0, s41, 1024
s_nop 0
buffer_load_dwordx4 v117, s[20:23], 0 offen nt lds
s_waitcnt vmcnt(2)
ds_read_b128 v[94:97], v118 offset:2048
ds_read_b128 v[98:101], v119 offset:2048
v_rcp_f16_sdwa v78, v78 dst_sel:WORD_1 dst_unused:UNUSED_PRESERVE src0_sel:WORD_1
v_rcp_f16_sdwa v79, v79 dst_sel:WORD_1 dst_unused:UNUSED_PRESERVE src0_sel:WORD_1
v_rcp_f16_sdwa v80, v80 dst_sel:WORD_1 dst_unused:UNUSED_PRESERVE src0_sel:WORD_1
v_rcp_f16_sdwa v81, v81 dst_sel:WORD_1 dst_unused:UNUSED_PRESERVE src0_sel:WORD_1
v_rcp_f16_sdwa v82, v82 dst_sel:WORD_1 dst_unused:UNUSED_PRESERVE src0_sel:WORD_1
v_rcp_f16_sdwa v83, v83 dst_sel:WORD_1 dst_unused:UNUSED_PRESERVE src0_sel:WORD_1
v_rcp_f16_sdwa v84, v84 dst_sel:WORD_1 dst_unused:UNUSED_PRESERVE src0_sel:WORD_1
v_rcp_f16_sdwa v85, v85 dst_sel:WORD_1 dst_unused:UNUSED_PRESERVE src0_sel:WORD_1
s_cmp_le_u32 s43, 5
s_nop 0
v_mfma_f32_16x16x32_f16 v[114:117], v[78:81], v[66:69], v[74:77]
v_mfma_f32_16x16x32_f16 v[114:117], v[82:85], v[70:73], v[114:117]
s_cbranch_scc1 L_drain_g
s_waitcnt lgkmcnt(0)
v_mfma_f32_16x16x32_bf16 v[78:81], v[2:5], v[94:97], v[34:37]
v_mfma_f32_16x16x32_bf16 v[78:81], v[6:9], v[98:101], v[78:81]
v_mfma_f32_16x16x32_bf16 v[82:85], v[10:13], v[94:97], v[38:41]
v_mfma_f32_16x16x32_bf16 v[82:85], v[14:17], v[98:101], v[82:85]
v_mfma_f32_16x16x32_bf16 v[86:89], v[18:21], v[94:97], v[42:45]
v_mfma_f32_16x16x32_bf16 v[86:89], v[22:25], v[98:101], v[86:89]
v_mfma_f32_16x16x32_bf16 v[90:93], v[26:29], v[94:97], v[46:49]
v_mfma_f32_16x16x32_bf16 v[90:93], v[30:33], v[98:101], v[90:93]
s_setprio 1
v_mul_f32 v114, v114, v110
v_mul_f32 v115, v115, v111
v_mul_f32 v116, v116, v112
v_mul_f32 v117, v117, v113
v_cvt_pk_bf16_f32 v114, v114, v115
v_cvt_pk_bf16_f32 v115, v116, v117
v_exp_f32 v78, v78
v_exp_f32 v79, v79
v_exp_f32 v80, v80
v_exp_f32 v81, v81
v_mfma_f32_4x4x4_16b_bf16 v[50:53], v[114:115], v[102:103], v[50:53]
v_exp_f32 v82, v82
v_exp_f32 v83, v83
v_exp_f32 v84, v84
v_exp_f32 v85, v85
v_mfma_f32_4x4x4_16b_bf16 v[54:57], v[114:115], v[104:105], v[54:57]
v_exp_f32 v86, v86
v_exp_f32 v87, v87
v_exp_f32 v88, v88
v_exp_f32 v89, v89
v_mfma_f32_4x4x4_16b_bf16 v[58:61], v[114:115], v[106:107], v[58:61]
v_exp_f32 v90, v90
v_exp_f32 v91, v91
v_exp_f32 v92, v92
v_exp_f32 v93, v93
v_mfma_f32_4x4x4_16b_bf16 v[62:65], v[114:115], v[108:109], v[62:65]
ds_read_b64_tr_b16 v[102:103], v120 offset:2048
ds_read_b64_tr_b16 v[104:105], v121 offset:2048
ds_read_b64_tr_b16 v[106:107], v122 offset:2048
ds_read_b64_tr_b16 v[108:109], v123 offset:2048
ds_read_b128 v[110:113], v125 offset:4928
ds_read_b32 v116, v124 offset:4320
v_cvt_pk_f16_f32 v78, v78, v79
v_cvt_pk_f16_f32 v79, v80, v81
v_cvt_pk_f16_f32 v80, v82, v83
v_cvt_pk_f16_f32 v81, v84, v85
v_cvt_pk_f16_f32 v82, v86, v87
v_cvt_pk_f16_f32 v83, v88, v89
v_cvt_pk_f16_f32 v84, v90, v91
v_cvt_pk_f16_f32 v85, v92, v93
v_pk_add_f16 v78, v78, s69
v_pk_add_f16 v79, v79, s69
v_pk_add_f16 v80, v80, s69
v_pk_add_f16 v81, v81, s69
v_pk_add_f16 v82, v82, s69
v_pk_add_f16 v83, v83, s69
v_pk_add_f16 v84, v84, s69
v_pk_add_f16 v85, v85, s69
v_rcp_f16_sdwa v78, v78 dst_sel:WORD_0 dst_unused:UNUSED_PRESERVE src0_sel:WORD_0
v_rcp_f16_sdwa v79, v79 dst_sel:WORD_0 dst_unused:UNUSED_PRESERVE src0_sel:WORD_0
v_rcp_f16_sdwa v80, v80 dst_sel:WORD_0 dst_unused:UNUSED_PRESERVE src0_sel:WORD_0
v_rcp_f16_sdwa v81, v81 dst_sel:WORD_0 dst_unused:UNUSED_PRESERVE src0_sel:WORD_0
v_rcp_f16_sdwa v82, v82 dst_sel:WORD_0 dst_unused:UNUSED_PRESERVE src0_sel:WORD_0
v_rcp_f16_sdwa v83, v83 dst_sel:WORD_0 dst_unused:UNUSED_PRESERVE src0_sel:WORD_0
v_rcp_f16_sdwa v84, v84 dst_sel:WORD_0 dst_unused:UNUSED_PRESERVE src0_sel:WORD_0
v_rcp_f16_sdwa v85, v85 dst_sel:WORD_0 dst_unused:UNUSED_PRESERVE src0_sel:WORD_0
s_waitcnt lgkmcnt(0)
v_add_u32_sdwa v117, v126, v116 dst_sel:DWORD dst_unused:UNUSED_PAD src0_sel:DWORD src1_sel:WORD_1
v_add_u32_sdwa v116, v126, v116 dst_sel:DWORD dst_unused:UNUSED_PAD src0_sel:DWORD src1_sel:WORD_0
s_add_u32 m0, s41, 2048
s_nop 0
buffer_load_dwordx4 v116, s[20:23], 0 offen nt lds
s_add_u32 m0, s41, 3072
s_nop 0
buffer_load_dwordx4 v117, s[20:23], 0 offen nt lds
s_waitcnt vmcnt(2)
ds_read_b128 v[94:97], v118 offset:0
ds_read_b128 v[98:101], v119 offset:0
v_rcp_f16_sdwa v78, v78 dst_sel:WORD_1 dst_unused:UNUSED_PRESERVE src0_sel:WORD_1
v_rcp_f16_sdwa v79, v79 dst_sel:WORD_1 dst_unused:UNUSED_PRESERVE src0_sel:WORD_1
v_rcp_f16_sdwa v80, v80 dst_sel:WORD_1 dst_unused:UNUSED_PRESERVE src0_sel:WORD_1
v_rcp_f16_sdwa v81, v81 dst_sel:WORD_1 dst_unused:UNUSED_PRESERVE src0_sel:WORD_1
v_rcp_f16_sdwa v82, v82 dst_sel:WORD_1 dst_unused:UNUSED_PRESERVE src0_sel:WORD_1
v_rcp_f16_sdwa v83, v83 dst_sel:WORD_1 dst_unused:UNUSED_PRESERVE src0_sel:WORD_1
v_rcp_f16_sdwa v84, v84 dst_sel:WORD_1 dst_unused:UNUSED_PRESERVE src0_sel:WORD_1
v_rcp_f16_sdwa v85, v85 dst_sel:WORD_1 dst_unused:UNUSED_PRESERVE src0_sel:WORD_1
s_cmp_le_u32 s43, 6
s_nop 0
v_mfma_f32_16x16x32_f16 v[114:117], v[78:81], v[66:69], v[74:77]
v_mfma_f32_16x16x32_f16 v[114:117], v[82:85], v[70:73], v[114:117]
s_cbranch_scc1 L_drain_g
s_waitcnt lgkmcnt(0)
v_mfma_f32_16x16x32_bf16 v[78:81], v[2:5], v[94:97], v[34:37]
v_mfma_f32_16x16x32_bf16 v[78:81], v[6:9], v[98:101], v[78:81]
v_mfma_f32_16x16x32_bf16 v[82:85], v[10:13], v[94:97], v[38:41]
v_mfma_f32_16x16x32_bf16 v[82:85], v[14:17], v[98:101], v[82:85]
v_mfma_f32_16x16x32_bf16 v[86:89], v[18:21], v[94:97], v[42:45]
v_mfma_f32_16x16x32_bf16 v[86:89], v[22:25], v[98:101], v[86:89]
v_mfma_f32_16x16x32_bf16 v[90:93], v[26:29], v[94:97], v[46:49]
v_mfma_f32_16x16x32_bf16 v[90:93], v[30:33], v[98:101], v[90:93]
s_setprio 0
v_mul_f32 v114, v114, v110
v_mul_f32 v115, v115, v111
v_mul_f32 v116, v116, v112
v_mul_f32 v117, v117, v113
v_cvt_pk_bf16_f32 v114, v114, v115
v_cvt_pk_bf16_f32 v115, v116, v117
v_exp_f32 v78, v78
v_exp_f32 v79, v79
v_exp_f32 v80, v80
v_exp_f32 v81, v81
v_mfma_f32_4x4x4_16b_bf16 v[50:53], v[114:115], v[102:103], v[50:53]
v_exp_f32 v82, v82
v_exp_f32 v83, v83
v_exp_f32 v84, v84
v_exp_f32 v85, v85
v_mfma_f32_4x4x4_16b_bf16 v[54:57], v[114:115], v[104:105], v[54:57]
v_exp_f32 v86, v86
v_exp_f32 v87, v87
v_exp_f32 v88, v88
v_exp_f32 v89, v89
v_mfma_f32_4x4x4_16b_bf16 v[58:61], v[114:115], v[106:107], v[58:61]
v_exp_f32 v90, v90
v_exp_f32 v91, v91
v_exp_f32 v92, v92
v_exp_f32 v93, v93
v_mfma_f32_4x4x4_16b_bf16 v[62:65], v[114:115], v[108:109], v[62:65]
ds_read_b64_tr_b16 v[102:103], v120 offset:0
ds_read_b64_tr_b16 v[104:105], v121 offset:0
ds_read_b64_tr_b16 v[106:107], v122 offset:0
ds_read_b64_tr_b16 v[108:109], v123 offset:0
ds_read_b128 v[110:113], v125 offset:4992
ds_read_b32 v116, v124 offset:4352
v_cvt_pk_f16_f32 v78, v78, v79
v_cvt_pk_f16_f32 v79, v80, v81
v_cvt_pk_f16_f32 v80, v82, v83
v_cvt_pk_f16_f32 v81, v84, v85
v_cvt_pk_f16_f32 v82, v86, v87
v_cvt_pk_f16_f32 v83, v88, v89
v_cvt_pk_f16_f32 v84, v90, v91
v_cvt_pk_f16_f32 v85, v92, v93
v_pk_add_f16 v78, v78, s69
v_pk_add_f16 v79, v79, s69
v_pk_add_f16 v80, v80, s69
v_pk_add_f16 v81, v81, s69
v_pk_add_f16 v82, v82, s69
v_pk_add_f16 v83, v83, s69
v_pk_add_f16 v84, v84, s69
v_pk_add_f16 v85, v85, s69
v_rcp_f16_sdwa v78, v78 dst_sel:WORD_0 dst_unused:UNUSED_PRESERVE src0_sel:WORD_0
v_rcp_f16_sdwa v79, v79 dst_sel:WORD_0 dst_unused:UNUSED_PRESERVE src0_sel:WORD_0
v_rcp_f16_sdwa v80, v80 dst_sel:WORD_0 dst_unused:UNUSED_PRESERVE src0_sel:WORD_0
v_rcp_f16_sdwa v81, v81 dst_sel:WORD_0 dst_unused:UNUSED_PRESERVE src0_sel:WORD_0
v_rcp_f16_sdwa v82, v82 dst_sel:WORD_0 dst_unused:UNUSED_PRESERVE src0_sel:WORD_0
v_rcp_f16_sdwa v83, v83 dst_sel:WORD_0 dst_unused:UNUSED_PRESERVE src0_sel:WORD_0
v_rcp_f16_sdwa v84, v84 dst_sel:WORD_0 dst_unused:UNUSED_PRESERVE src0_sel:WORD_0
v_rcp_f16_sdwa v85, v85 dst_sel:WORD_0 dst_unused:UNUSED_PRESERVE src0_sel:WORD_0
s_waitcnt lgkmcnt(0)
v_add_u32_sdwa v117, v126, v116 dst_sel:DWORD dst_unused:UNUSED_PAD src0_sel:DWORD src1_sel:WORD_1
v_add_u32_sdwa v116, v126, v116 dst_sel:DWORD dst_unused:UNUSED_PAD src0_sel:DWORD src1_sel:WORD_0
s_add_u32 m0, s41, 0
s_nop 0
buffer_load_dwordx4 v116, s[20:23], 0 offen nt lds
s_add_u32 m0, s41, 1024
s_nop 0
buffer_load_dwordx4 v117, s[20:23], 0 offen nt lds
s_waitcnt vmcnt(2)
ds_read_b128 v[94:97], v118 offset:2048
ds_read_b128 v[98:101], v119 offset:2048
v_rcp_f16_sdwa v78, v78 dst_sel:WORD_1 dst_unused:UNUSED_PRESERVE src0_sel:WORD_1
v_rcp_f16_sdwa v79, v79 dst_sel:WORD_1 dst_unused:UNUSED_PRESERVE src0_sel:WORD_1
v_rcp_f16_sdwa v80, v80 dst_sel:WORD_1 dst_unused:UNUSED_PRESERVE src0_sel:WORD_1
v_rcp_f16_sdwa v81, v81 dst_sel:WORD_1 dst_unused:UNUSED_PRESERVE src0_sel:WORD_1
v_rcp_f16_sdwa v82, v82 dst_sel:WORD_1 dst_unused:UNUSED_PRESERVE src0_sel:WORD_1
v_rcp_f16_sdwa v83, v83 dst_sel:WORD_1 dst_unused:UNUSED_PRESERVE src0_sel:WORD_1
v_rcp_f16_sdwa v84, v84 dst_sel:WORD_1 dst_unused:UNUSED_PRESERVE src0_sel:WORD_1
v_rcp_f16_sdwa v85, v85 dst_sel:WORD_1 dst_unused:UNUSED_PRESERVE src0_sel:WORD_1
s_cmp_le_u32 s43, 7
s_nop 0
v_mfma_f32_16x16x32_f16 v[114:117], v[78:81], v[66:69], v[74:77]
v_mfma_f32_16x16x32_f16 v[114:117], v[82:85], v[70:73], v[114:117]
s_cbranch_scc1 L_drain_g
s_waitcnt lgkmcnt(0)
v_mfma_f32_16x16x32_bf16 v[78:81], v[2:5], v[94:97], v[34:37]
v_mfma_f32_16x16x32_bf16 v[78:81], v[6:9], v[98:101], v[78:81]
v_mfma_f32_16x16x32_bf16 v[82:85], v[10:13], v[94:97], v[38:41]
v_mfma_f32_16x16x32_bf16 v[82:85], v[14:17], v[98:101], v[82:85]
v_mfma_f32_16x16x32_bf16 v[86:89], v[18:21], v[94:97], v[42:45]
v_mfma_f32_16x16x32_bf16 v[86:89], v[22:25], v[98:101], v[86:89]
v_mfma_f32_16x16x32_bf16 v[90:93], v[26:29], v[94:97], v[46:49]
v_mfma_f32_16x16x32_bf16 v[90:93], v[30:33], v[98:101], v[90:93]
v_mul_f32 v114, v114, v110
v_mul_f32 v115, v115, v111
v_mul_f32 v116, v116, v112
v_mul_f32 v117, v117, v113
v_cvt_pk_bf16_f32 v114, v114, v115
v_cvt_pk_bf16_f32 v115, v116, v117
v_exp_f32 v78, v78
v_exp_f32 v79, v79
v_exp_f32 v80, v80
v_exp_f32 v81, v81
v_mfma_f32_4x4x4_16b_bf16 v[50:53], v[114:115], v[102:103], v[50:53]
v_exp_f32 v82, v82
v_exp_f32 v83, v83
v_exp_f32 v84, v84
v_exp_f32 v85, v85
v_mfma_f32_4x4x4_16b_bf16 v[54:57], v[114:115], v[104:105], v[54:57]
v_exp_f32 v86, v86
v_exp_f32 v87, v87
v_exp_f32 v88, v88
v_exp_f32 v89, v89
v_mfma_f32_4x4x4_16b_bf16 v[58:61], v[114:115], v[106:107], v[58:61]
v_exp_f32 v90, v90
v_exp_f32 v91, v91
v_exp_f32 v92, v92
v_exp_f32 v93, v93
v_mfma_f32_4x4x4_16b_bf16 v[62:65], v[114:115], v[108:109], v[62:65]
ds_read_b64_tr_b16 v[102:103], v120 offset:2048
ds_read_b64_tr_b16 v[104:105], v121 offset:2048
ds_read_b64_tr_b16 v[106:107], v122 offset:2048
ds_read_b64_tr_b16 v[108:109], v123 offset:2048
ds_read_b128 v[110:113], v125 offset:5056
ds_read_b32 v116, v124 offset:4384
v_cvt_pk_f16_f32 v78, v78, v79
v_cvt_pk_f16_f32 v79, v80, v81
v_cvt_pk_f16_f32 v80, v82, v83
v_cvt_pk_f16_f32 v81, v84, v85
v_cvt_pk_f16_f32 v82, v86, v87
v_cvt_pk_f16_f32 v83, v88, v89
v_cvt_pk_f16_f32 v84, v90, v91
v_cvt_pk_f16_f32 v85, v92, v93
v_pk_add_f16 v78, v78, s69
v_pk_add_f16 v79, v79, s69
v_pk_add_f16 v80, v80, s69
v_pk_add_f16 v81, v81, s69
v_pk_add_f16 v82, v82, s69
v_pk_add_f16 v83, v83, s69
v_pk_add_f16 v84, v84, s69
v_pk_add_f16 v85, v85, s69
v_rcp_f16_sdwa v78, v78 dst_sel:WORD_0 dst_unused:UNUSED_PRESERVE src0_sel:WORD_0
v_rcp_f16_sdwa v79, v79 dst_sel:WORD_0 dst_unused:UNUSED_PRESERVE src0_sel:WORD_0
v_rcp_f16_sdwa v80, v80 dst_sel:WORD_0 dst_unused:UNUSED_PRESERVE src0_sel:WORD_0
v_rcp_f16_sdwa v81, v81 dst_sel:WORD_0 dst_unused:UNUSED_PRESERVE src0_sel:WORD_0
v_rcp_f16_sdwa v82, v82 dst_sel:WORD_0 dst_unused:UNUSED_PRESERVE src0_sel:WORD_0
v_rcp_f16_sdwa v83, v83 dst_sel:WORD_0 dst_unused:UNUSED_PRESERVE src0_sel:WORD_0
v_rcp_f16_sdwa v84, v84 dst_sel:WORD_0 dst_unused:UNUSED_PRESERVE src0_sel:WORD_0
v_rcp_f16_sdwa v85, v85 dst_sel:WORD_0 dst_unused:UNUSED_PRESERVE src0_sel:WORD_0
s_waitcnt lgkmcnt(0)
v_add_u32_sdwa v117, v126, v116 dst_sel:DWORD dst_unused:UNUSED_PAD src0_sel:DWORD src1_sel:WORD_1
v_add_u32_sdwa v116, v126, v116 dst_sel:DWORD dst_unused:UNUSED_PAD src0_sel:DWORD src1_sel:WORD_0
s_add_u32 m0, s41, 2048
s_nop 0
buffer_load_dwordx4 v116, s[20:23], 0 offen nt lds
s_add_u32 m0, s41, 3072
s_nop 0
buffer_load_dwordx4 v117, s[20:23], 0 offen nt lds
s_waitcnt vmcnt(2)
ds_read_b128 v[94:97], v118 offset:0
ds_read_b128 v[98:101], v119 offset:0
v_rcp_f16_sdwa v78, v78 dst_sel:WORD_1 dst_unused:UNUSED_PRESERVE src0_sel:WORD_1
v_rcp_f16_sdwa v79, v79 dst_sel:WORD_1 dst_unused:UNUSED_PRESERVE src0_sel:WORD_1
v_rcp_f16_sdwa v80, v80 dst_sel:WORD_1 dst_unused:UNUSED_PRESERVE src0_sel:WORD_1
v_rcp_f16_sdwa v81, v81 dst_sel:WORD_1 dst_unused:UNUSED_PRESERVE src0_sel:WORD_1
v_rcp_f16_sdwa v82, v82 dst_sel:WORD_1 dst_unused:UNUSED_PRESERVE src0_sel:WORD_1
v_rcp_f16_sdwa v83, v83 dst_sel:WORD_1 dst_unused:UNUSED_PRESERVE src0_sel:WORD_1
v_rcp_f16_sdwa v84, v84 dst_sel:WORD_1 dst_unused:UNUSED_PRESERVE src0_sel:WORD_1
v_rcp_f16_sdwa v85, v85 dst_sel:WORD_1 dst_unused:UNUSED_PRESERVE src0_sel:WORD_1
s_cmp_le_u32 s43, 8
s_nop 0
v_mfma_f32_16x16x32_f16 v[114:117], v[78:81], v[66:69], v[74:77]
v_mfma_f32_16x16x32_f16 v[114:117], v[82:85], v[70:73], v[114:117]
s_cbranch_scc1 L_drain_g
s_waitcnt lgkmcnt(0)
v_mfma_f32_16x16x32_bf16 v[78:81], v[2:5], v[94:97], v[34:37]
v_mfma_f32_16x16x32_bf16 v[78:81], v[6:9], v[98:101], v[78:81]
v_mfma_f32_16x16x32_bf16 v[82:85], v[10:13], v[94:97], v[38:41]
v_mfma_f32_16x16x32_bf16 v[82:85], v[14:17], v[98:101], v[82:85]
v_mfma_f32_16x16x32_bf16 v[86:89], v[18:21], v[94:97], v[42:45]
v_mfma_f32_16x16x32_bf16 v[86:89], v[22:25], v[98:101], v[86:89]
v_mfma_f32_16x16x32_bf16 v[90:93], v[26:29], v[94:97], v[46:49]
v_mfma_f32_16x16x32_bf16 v[90:93], v[30:33], v[98:101], v[90:93]
v_mul_f32 v114, v114, v110
v_mul_f32 v115, v115, v111
v_mul_f32 v116, v116, v112
v_mul_f32 v117, v117, v113
v_cvt_pk_bf16_f32 v114, v114, v115
v_cvt_pk_bf16_f32 v115, v116, v117
v_exp_f32 v78, v78
v_exp_f32 v79, v79
v_exp_f32 v80, v80
v_exp_f32 v81, v81
v_mfma_f32_4x4x4_16b_bf16 v[50:53], v[114:115], v[102:103], v[50:53]
v_exp_f32 v82, v82
v_exp_f32 v83, v83
v_exp_f32 v84, v84
v_exp_f32 v85, v85
v_mfma_f32_4x4x4_16b_bf16 v[54:57], v[114:115], v[104:105], v[54:57]
v_exp_f32 v86, v86
v_exp_f32 v87, v87
v_exp_f32 v88, v88
v_exp_f32 v89, v89
v_mfma_f32_4x4x4_16b_bf16 v[58:61], v[114:115], v[106:107], v[58:61]
v_exp_f32 v90, v90
v_exp_f32 v91, v91
v_exp_f32 v92, v92
v_exp_f32 v93, v93
v_mfma_f32_4x4x4_16b_bf16 v[62:65], v[114:115], v[108:109], v[62:65]
ds_read_b64_tr_b16 v[102:103], v120 offset:0
ds_read_b64_tr_b16 v[104:105], v121 offset:0
ds_read_b64_tr_b16 v[106:107], v122 offset:0
ds_read_b64_tr_b16 v[108:109], v123 offset:0
ds_read_b128 v[110:113], v125 offset:5120
ds_read_b32 v116, v124 offset:4416
v_cvt_pk_f16_f32 v78, v78, v79
v_cvt_pk_f16_f32 v79, v80, v81
v_cvt_pk_f16_f32 v80, v82, v83
v_cvt_pk_f16_f32 v81, v84, v85
v_cvt_pk_f16_f32 v82, v86, v87
v_cvt_pk_f16_f32 v83, v88, v89
v_cvt_pk_f16_f32 v84, v90, v91
v_cvt_pk_f16_f32 v85, v92, v93
v_pk_add_f16 v78, v78, s69
v_pk_add_f16 v79, v79, s69
v_pk_add_f16 v80, v80, s69
v_pk_add_f16 v81, v81, s69
v_pk_add_f16 v82, v82, s69
v_pk_add_f16 v83, v83, s69
v_pk_add_f16 v84, v84, s69
v_pk_add_f16 v85, v85, s69
v_rcp_f16_sdwa v78, v78 dst_sel:WORD_0 dst_unused:UNUSED_PRESERVE src0_sel:WORD_0
v_rcp_f16_sdwa v79, v79 dst_sel:WORD_0 dst_unused:UNUSED_PRESERVE src0_sel:WORD_0
v_rcp_f16_sdwa v80, v80 dst_sel:WORD_0 dst_unused:UNUSED_PRESERVE src0_sel:WORD_0
v_rcp_f16_sdwa v81, v81 dst_sel:WORD_0 dst_unused:UNUSED_PRESERVE src0_sel:WORD_0
v_rcp_f16_sdwa v82, v82 dst_sel:WORD_0 dst_unused:UNUSED_PRESERVE src0_sel:WORD_0
v_rcp_f16_sdwa v83, v83 dst_sel:WORD_0 dst_unused:UNUSED_PRESERVE src0_sel:WORD_0
v_rcp_f16_sdwa v84, v84 dst_sel:WORD_0 dst_unused:UNUSED_PRESERVE src0_sel:WORD_0
v_rcp_f16_sdwa v85, v85 dst_sel:WORD_0 dst_unused:UNUSED_PRESERVE src0_sel:WORD_0
s_waitcnt lgkmcnt(0)
v_add_u32_sdwa v117, v126, v116 dst_sel:DWORD dst_unused:UNUSED_PAD src0_sel:DWORD src1_sel:WORD_1
v_add_u32_sdwa v116, v126, v116 dst_sel:DWORD dst_unused:UNUSED_PAD src0_sel:DWORD src1_sel:WORD_0
s_add_u32 m0, s41, 0
s_nop 0
buffer_load_dwordx4 v116, s[20:23], 0 offen nt lds
s_add_u32 m0, s41, 1024
s_nop 0
buffer_load_dwordx4 v117, s[20:23], 0 offen nt lds
s_waitcnt vmcnt(2)
ds_read_b128 v[94:97], v118 offset:2048
ds_read_b128 v[98:101], v119 offset:2048
v_rcp_f16_sdwa v78, v78 dst_sel:WORD_1 dst_unused:UNUSED_PRESERVE src0_sel:WORD_1
v_rcp_f16_sdwa v79, v79 dst_sel:WORD_1 dst_unused:UNUSED_PRESERVE src0_sel:WORD_1
v_rcp_f16_sdwa v80, v80 dst_sel:WORD_1 dst_unused:UNUSED_PRESERVE src0_sel:WORD_1
v_rcp_f16_sdwa v81, v81 dst_sel:WORD_1 dst_unused:UNUSED_PRESERVE src0_sel:WORD_1
v_rcp_f16_sdwa v82, v82 dst_sel:WORD_1 dst_unused:UNUSED_PRESERVE src0_sel:WORD_1
v_rcp_f16_sdwa v83, v83 dst_sel:WORD_1 dst_unused:UNUSED_PRESERVE src0_sel:WORD_1
v_rcp_f16_sdwa v84, v84 dst_sel:WORD_1 dst_unused:UNUSED_PRESERVE src0_sel:WORD_1
v_rcp_f16_sdwa v85, v85 dst_sel:WORD_1 dst_unused:UNUSED_PRESERVE src0_sel:WORD_1
s_cmp_le_u32 s43, 9
s_nop 0
v_mfma_f32_16x16x32_f16 v[114:117], v[78:81], v[66:69], v[74:77]
v_mfma_f32_16x16x32_f16 v[114:117], v[82:85], v[70:73], v[114:117]
s_cbranch_scc1 L_drain_g
s_waitcnt lgkmcnt(0)
v_mfma_f32_16x16x32_bf16 v[78:81], v[2:5], v[94:97], v[34:37]
v_mfma_f32_16x16x32_bf16 v[78:81], v[6:9], v[98:101], v[78:81]
v_mfma_f32_16x16x32_bf16 v[82:85], v[10:13], v[94:97], v[38:41]
v_mfma_f32_16x16x32_bf16 v[82:85], v[14:17], v[98:101], v[82:85]
v_mfma_f32_16x16x32_bf16 v[86:89], v[18:21], v[94:97], v[42:45]
v_mfma_f32_16x16x32_bf16 v[86:89], v[22:25], v[98:101], v[86:89]
v_mfma_f32_16x16x32_bf16 v[90:93], v[26:29], v[94:97], v[46:49]
v_mfma_f32_16x16x32_bf16 v[90:93], v[30:33], v[98:101], v[90:93]
v_mul_f32 v114, v114, v110
v_mul_f32 v115, v115, v111
v_mul_f32 v116, v116, v112
v_mul_f32 v117, v117, v113
v_cvt_pk_bf16_f32 v114, v114, v115
v_cvt_pk_bf16_f32 v115, v116, v117
v_exp_f32 v78, v78
v_exp_f32 v79, v79
v_exp_f32 v80, v80
v_exp_f32 v81, v81
v_mfma_f32_4x4x4_16b_bf16 v[50:53], v[114:115], v[102:103], v[50:53]
v_exp_f32 v82, v82
v_exp_f32 v83, v83
v_exp_f32 v84, v84
v_exp_f32 v85, v85
v_mfma_f32_4x4x4_16b_bf16 v[54:57], v[114:115], v[104:105], v[54:57]
v_exp_f32 v86, v86
v_exp_f32 v87, v87
v_exp_f32 v88, v88
v_exp_f32 v89, v89
v_mfma_f32_4x4x4_16b_bf16 v[58:61], v[114:115], v[106:107], v[58:61]
v_exp_f32 v90, v90
v_exp_f32 v91, v91
v_exp_f32 v92, v92
v_exp_f32 v93, v93
v_mfma_f32_4x4x4_16b_bf16 v[62:65], v[114:115], v[108:109], v[62:65]
ds_read_b64_tr_b16 v[102:103], v120 offset:2048
ds_read_b64_tr_b16 v[104:105], v121 offset:2048
ds_read_b64_tr_b16 v[106:107], v122 offset:2048
ds_read_b64_tr_b16 v[108:109], v123 offset:2048
ds_read_b128 v[110:113], v125 offset:5184
ds_read_b32 v116, v124 offset:4448
v_cvt_pk_f16_f32 v78, v78, v79
v_cvt_pk_f16_f32 v79, v80, v81
v_cvt_pk_f16_f32 v80, v82, v83
v_cvt_pk_f16_f32 v81, v84, v85
v_cvt_pk_f16_f32 v82, v86, v87
v_cvt_pk_f16_f32 v83, v88, v89
v_cvt_pk_f16_f32 v84, v90, v91
v_cvt_pk_f16_f32 v85, v92, v93
v_pk_add_f16 v78, v78, s69
v_pk_add_f16 v79, v79, s69
v_pk_add_f16 v80, v80, s69
v_pk_add_f16 v81, v81, s69
v_pk_add_f16 v82, v82, s69
v_pk_add_f16 v83, v83, s69
v_pk_add_f16 v84, v84, s69
v_pk_add_f16 v85, v85, s69
v_rcp_f16_sdwa v78, v78 dst_sel:WORD_0 dst_unused:UNUSED_PRESERVE src0_sel:WORD_0
v_rcp_f16_sdwa v79, v79 dst_sel:WORD_0 dst_unused:UNUSED_PRESERVE src0_sel:WORD_0
v_rcp_f16_sdwa v80, v80 dst_sel:WORD_0 dst_unused:UNUSED_PRESERVE src0_sel:WORD_0
v_rcp_f16_sdwa v81, v81 dst_sel:WORD_0 dst_unused:UNUSED_PRESERVE src0_sel:WORD_0
v_rcp_f16_sdwa v82, v82 dst_sel:WORD_0 dst_unused:UNUSED_PRESERVE src0_sel:WORD_0
v_rcp_f16_sdwa v83, v83 dst_sel:WORD_0 dst_unused:UNUSED_PRESERVE src0_sel:WORD_0
v_rcp_f16_sdwa v84, v84 dst_sel:WORD_0 dst_unused:UNUSED_PRESERVE src0_sel:WORD_0
v_rcp_f16_sdwa v85, v85 dst_sel:WORD_0 dst_unused:UNUSED_PRESERVE src0_sel:WORD_0
s_waitcnt lgkmcnt(0)
v_add_u32_sdwa v117, v126, v116 dst_sel:DWORD dst_unused:UNUSED_PAD src0_sel:DWORD src1_sel:WORD_1
v_add_u32_sdwa v116, v126, v116 dst_sel:DWORD dst_unused:UNUSED_PAD src0_sel:DWORD src1_sel:WORD_0
s_add_u32 m0, s41, 2048
s_nop 0
buffer_load_dwordx4 v116, s[20:23], 0 offen nt lds
s_add_u32 m0, s41, 3072
s_nop 0
buffer_load_dwordx4 v117, s[20:23], 0 offen nt lds
s_waitcnt vmcnt(2)
ds_read_b128 v[94:97], v118 offset:0
ds_read_b128 v[98:101], v119 offset:0
v_rcp_f16_sdwa v78, v78 dst_sel:WORD_1 dst_unused:UNUSED_PRESERVE src0_sel:WORD_1
v_rcp_f16_sdwa v79, v79 dst_sel:WORD_1 dst_unused:UNUSED_PRESERVE src0_sel:WORD_1
v_rcp_f16_sdwa v80, v80 dst_sel:WORD_1 dst_unused:UNUSED_PRESERVE src0_sel:WORD_1
v_rcp_f16_sdwa v81, v81 dst_sel:WORD_1 dst_unused:UNUSED_PRESERVE src0_sel:WORD_1
v_rcp_f16_sdwa v82, v82 dst_sel:WORD_1 dst_unused:UNUSED_PRESERVE src0_sel:WORD_1
v_rcp_f16_sdwa v83, v83 dst_sel:WORD_1 dst_unused:UNUSED_PRESERVE src0_sel:WORD_1
v_rcp_f16_sdwa v84, v84 dst_sel:WORD_1 dst_unused:UNUSED_PRESERVE src0_sel:WORD_1
v_rcp_f16_sdwa v85, v85 dst_sel:WORD_1 dst_unused:UNUSED_PRESERVE src0_sel:WORD_1
s_cmp_le_u32 s43, 10
s_nop 0
v_mfma_f32_16x16x32_f16 v[114:117], v[78:81], v[66:69], v[74:77]
v_mfma_f32_16x16x32_f16 v[114:117], v[82:85], v[70:73], v[114:117]
s_cbranch_scc1 L_drain_g
s_waitcnt lgkmcnt(0)
v_mfma_f32_16x16x32_bf16 v[78:81], v[2:5], v[94:97], v[34:37]
v_mfma_f32_16x16x32_bf16 v[78:81], v[6:9], v[98:101], v[78:81]
v_mfma_f32_16x16x32_bf16 v[82:85], v[10:13], v[94:97], v[38:41]
v_mfma_f32_16x16x32_bf16 v[82:85], v[14:17], v[98:101], v[82:85]
v_mfma_f32_16x16x32_bf16 v[86:89], v[18:21], v[94:97], v[42:45]
v_mfma_f32_16x16x32_bf16 v[86:89], v[22:25], v[98:101], v[86:89]
v_mfma_f32_16x16x32_bf16 v[90:93], v[26:29], v[94:97], v[46:49]
v_mfma_f32_16x16x32_bf16 v[90:93], v[30:33], v[98:101], v[90:93]
v_mul_f32 v114, v114, v110
v_mul_f32 v115, v115, v111
v_mul_f32 v116, v116, v112
v_mul_f32 v117, v117, v113
v_cvt_pk_bf16_f32 v114, v114, v115
v_cvt_pk_bf16_f32 v115, v116, v117
v_exp_f32 v78, v78
v_exp_f32 v79, v79
v_exp_f32 v80, v80
v_exp_f32 v81, v81
v_mfma_f32_4x4x4_16b_bf16 v[50:53], v[114:115], v[102:103], v[50:53]
v_exp_f32 v82, v82
v_exp_f32 v83, v83
v_exp_f32 v84, v84
v_exp_f32 v85, v85
v_mfma_f32_4x4x4_16b_bf16 v[54:57], v[114:115], v[104:105], v[54:57]
v_exp_f32 v86, v86
v_exp_f32 v87, v87
v_exp_f32 v88, v88
v_exp_f32 v89, v89
v_mfma_f32_4x4x4_16b_bf16 v[58:61], v[114:115], v[106:107], v[58:61]
v_exp_f32 v90, v90
v_exp_f32 v91, v91
v_exp_f32 v92, v92
v_exp_f32 v93, v93
v_mfma_f32_4x4x4_16b_bf16 v[62:65], v[114:115], v[108:109], v[62:65]
ds_read_b64_tr_b16 v[102:103], v120 offset:0
ds_read_b64_tr_b16 v[104:105], v121 offset:0
ds_read_b64_tr_b16 v[106:107], v122 offset:0
ds_read_b64_tr_b16 v[108:109], v123 offset:0
ds_read_b128 v[110:113], v125 offset:5248
ds_read_b32 v116, v124 offset:4480
v_cvt_pk_f16_f32 v78, v78, v79
v_cvt_pk_f16_f32 v79, v80, v81
v_cvt_pk_f16_f32 v80, v82, v83
v_cvt_pk_f16_f32 v81, v84, v85
v_cvt_pk_f16_f32 v82, v86, v87
v_cvt_pk_f16_f32 v83, v88, v89
v_cvt_pk_f16_f32 v84, v90, v91
v_cvt_pk_f16_f32 v85, v92, v93
v_pk_add_f16 v78, v78, s69
v_pk_add_f16 v79, v79, s69
v_pk_add_f16 v80, v80, s69
v_pk_add_f16 v81, v81, s69
v_pk_add_f16 v82, v82, s69
v_pk_add_f16 v83, v83, s69
v_pk_add_f16 v84, v84, s69
v_pk_add_f16 v85, v85, s69
v_rcp_f16_sdwa v78, v78 dst_sel:WORD_0 dst_unused:UNUSED_PRESERVE src0_sel:WORD_0
v_rcp_f16_sdwa v79, v79 dst_sel:WORD_0 dst_unused:UNUSED_PRESERVE src0_sel:WORD_0
v_rcp_f16_sdwa v80, v80 dst_sel:WORD_0 dst_unused:UNUSED_PRESERVE src0_sel:WORD_0
v_rcp_f16_sdwa v81, v81 dst_sel:WORD_0 dst_unused:UNUSED_PRESERVE src0_sel:WORD_0
v_rcp_f16_sdwa v82, v82 dst_sel:WORD_0 dst_unused:UNUSED_PRESERVE src0_sel:WORD_0
v_rcp_f16_sdwa v83, v83 dst_sel:WORD_0 dst_unused:UNUSED_PRESERVE src0_sel:WORD_0
v_rcp_f16_sdwa v84, v84 dst_sel:WORD_0 dst_unused:UNUSED_PRESERVE src0_sel:WORD_0
v_rcp_f16_sdwa v85, v85 dst_sel:WORD_0 dst_unused:UNUSED_PRESERVE src0_sel:WORD_0
s_waitcnt lgkmcnt(0)
v_add_u32_sdwa v117, v126, v116 dst_sel:DWORD dst_unused:UNUSED_PAD src0_sel:DWORD src1_sel:WORD_1
v_add_u32_sdwa v116, v126, v116 dst_sel:DWORD dst_unused:UNUSED_PAD src0_sel:DWORD src1_sel:WORD_0
s_add_u32 m0, s41, 0
s_nop 0
buffer_load_dwordx4 v116, s[20:23], 0 offen nt lds
s_add_u32 m0, s41, 1024
s_nop 0
buffer_load_dwordx4 v117, s[20:23], 0 offen nt lds
s_waitcnt vmcnt(2)
ds_read_b128 v[94:97], v118 offset:2048
ds_read_b128 v[98:101], v119 offset:2048
v_rcp_f16_sdwa v78, v78 dst_sel:WORD_1 dst_unused:UNUSED_PRESERVE src0_sel:WORD_1
v_rcp_f16_sdwa v79, v79 dst_sel:WORD_1 dst_unused:UNUSED_PRESERVE src0_sel:WORD_1
v_rcp_f16_sdwa v80, v80 dst_sel:WORD_1 dst_unused:UNUSED_PRESERVE src0_sel:WORD_1
v_rcp_f16_sdwa v81, v81 dst_sel:WORD_1 dst_unused:UNUSED_PRESERVE src0_sel:WORD_1
v_rcp_f16_sdwa v82, v82 dst_sel:WORD_1 dst_unused:UNUSED_PRESERVE src0_sel:WORD_1
v_rcp_f16_sdwa v83, v83 dst_sel:WORD_1 dst_unused:UNUSED_PRESERVE src0_sel:WORD_1
v_rcp_f16_sdwa v84, v84 dst_sel:WORD_1 dst_unused:UNUSED_PRESERVE src0_sel:WORD_1
v_rcp_f16_sdwa v85, v85 dst_sel:WORD_1 dst_unused:UNUSED_PRESERVE src0_sel:WORD_1
s_cmp_le_u32 s43, 11
s_nop 0
v_mfma_f32_16x16x32_f16 v[114:117], v[78:81], v[66:69], v[74:77]
v_mfma_f32_16x16x32_f16 v[114:117], v[82:85], v[70:73], v[114:117]
s_cbranch_scc1 L_drain_g
s_waitcnt lgkmcnt(0)
v_mfma_f32_16x16x32_bf16 v[78:81], v[2:5], v[94:97], v[34:37]
v_mfma_f32_16x16x32_bf16 v[78:81], v[6:9], v[98:101], v[78:81]
v_mfma_f32_16x16x32_bf16 v[82:85], v[10:13], v[94:97], v[38:41]
v_mfma_f32_16x16x32_bf16 v[82:85], v[14:17], v[98:101], v[82:85]
v_mfma_f32_16x16x32_bf16 v[86:89], v[18:21], v[94:97], v[42:45]
v_mfma_f32_16x16x32_bf16 v[86:89], v[22:25], v[98:101], v[86:89]
v_mfma_f32_16x16x32_bf16 v[90:93], v[26:29], v[94:97], v[46:49]
v_mfma_f32_16x16x32_bf16 v[90:93], v[30:33], v[98:101], v[90:93]
v_mul_f32 v114, v114, v110
v_mul_f32 v115, v115, v111
v_mul_f32 v116, v116, v112
v_mul_f32 v117, v117, v113
v_cvt_pk_bf16_f32 v114, v114, v115
v_cvt_pk_bf16_f32 v115, v116, v117
v_exp_f32 v78, v78
v_exp_f32 v79, v79
v_exp_f32 v80, v80
v_exp_f32 v81, v81
v_mfma_f32_4x4x4_16b_bf16 v[50:53], v[114:115], v[102:103], v[50:53]
v_exp_f32 v82, v82
v_exp_f32 v83, v83
v_exp_f32 v84, v84
v_exp_f32 v85, v85
v_mfma_f32_4x4x4_16b_bf16 v[54:57], v[114:115], v[104:105], v[54:57]
v_exp_f32 v86, v86
v_exp_f32 v87, v87
v_exp_f32 v88, v88
v_exp_f32 v89, v89
v_mfma_f32_4x4x4_16b_bf16 v[58:61], v[114:115], v[106:107], v[58:61]
v_exp_f32 v90, v90
v_exp_f32 v91, v91
v_exp_f32 v92, v92
v_exp_f32 v93, v93
v_mfma_f32_4x4x4_16b_bf16 v[62:65], v[114:115], v[108:109], v[62:65]
ds_read_b64_tr_b16 v[102:103], v120 offset:2048
ds_read_b64_tr_b16 v[104:105], v121 offset:2048
ds_read_b64_tr_b16 v[106:107], v122 offset:2048
ds_read_b64_tr_b16 v[108:109], v123 offset:2048
ds_read_b128 v[110:113], v125 offset:5312
v_cvt_pk_f16_f32 v78, v78, v79
v_cvt_pk_f16_f32 v79, v80, v81
v_cvt_pk_f16_f32 v80, v82, v83
v_cvt_pk_f16_f32 v81, v84, v85
v_cvt_pk_f16_f32 v82, v86, v87
v_cvt_pk_f16_f32 v83, v88, v89
v_cvt_pk_f16_f32 v84, v90, v91
v_cvt_pk_f16_f32 v85, v92, v93
v_pk_add_f16 v78, v78, s69
v_pk_add_f16 v79, v79, s69
v_pk_add_f16 v80, v80, s69
v_pk_add_f16 v81, v81, s69
v_pk_add_f16 v82, v82, s69
v_pk_add_f16 v83, v83, s69
v_pk_add_f16 v84, v84, s69
v_pk_add_f16 v85, v85, s69
v_rcp_f16_sdwa v78, v78 dst_sel:WORD_0 dst_unused:UNUSED_PRESERVE src0_sel:WORD_0
v_rcp_f16_sdwa v79, v79 dst_sel:WORD_0 dst_unused:UNUSED_PRESERVE src0_sel:WORD_0
v_rcp_f16_sdwa v80, v80 dst_sel:WORD_0 dst_unused:UNUSED_PRESERVE src0_sel:WORD_0
v_rcp_f16_sdwa v81, v81 dst_sel:WORD_0 dst_unused:UNUSED_PRESERVE src0_sel:WORD_0
v_rcp_f16_sdwa v82, v82 dst_sel:WORD_0 dst_unused:UNUSED_PRESERVE src0_sel:WORD_0
v_rcp_f16_sdwa v83, v83 dst_sel:WORD_0 dst_unused:UNUSED_PRESERVE src0_sel:WORD_0
v_rcp_f16_sdwa v84, v84 dst_sel:WORD_0 dst_unused:UNUSED_PRESERVE src0_sel:WORD_0
v_rcp_f16_sdwa v85, v85 dst_sel:WORD_0 dst_unused:UNUSED_PRESERVE src0_sel:WORD_0
s_waitcnt vmcnt(0)
ds_read_b128 v[94:97], v118 offset:0
ds_read_b128 v[98:101], v119 offset:0
v_rcp_f16_sdwa v78, v78 dst_sel:WORD_1 dst_unused:UNUSED_PRESERVE src0_sel:WORD_1
v_rcp_f16_sdwa v79, v79 dst_sel:WORD_1 dst_unused:UNUSED_PRESERVE src0_sel:WORD_1
v_rcp_f16_sdwa v80, v80 dst_sel:WORD_1 dst_unused:UNUSED_PRESERVE src0_sel:WORD_1
v_rcp_f16_sdwa v81, v81 dst_sel:WORD_1 dst_unused:UNUSED_PRESERVE src0_sel:WORD_1
v_rcp_f16_sdwa v82, v82 dst_sel:WORD_1 dst_unused:UNUSED_PRESERVE src0_sel:WORD_1
v_rcp_f16_sdwa v83, v83 dst_sel:WORD_1 dst_unused:UNUSED_PRESERVE src0_sel:WORD_1
v_rcp_f16_sdwa v84, v84 dst_sel:WORD_1 dst_unused:UNUSED_PRESERVE src0_sel:WORD_1
v_rcp_f16_sdwa v85, v85 dst_sel:WORD_1 dst_unused:UNUSED_PRESERVE src0_sel:WORD_1
s_cmp_le_u32 s43, 12
s_nop 0
v_mfma_f32_16x16x32_f16 v[114:117], v[78:81], v[66:69], v[74:77]
v_mfma_f32_16x16x32_f16 v[114:117], v[82:85], v[70:73], v[114:117]
s_cbranch_scc1 L_drain_g
s_waitcnt lgkmcnt(0)
v_mfma_f32_16x16x32_bf16 v[78:81], v[2:5], v[94:97], v[34:37]
v_mfma_f32_16x16x32_bf16 v[78:81], v[6:9], v[98:101], v[78:81]
v_mfma_f32_16x16x32_bf16 v[82:85], v[10:13], v[94:97], v[38:41]
v_mfma_f32_16x16x32_bf16 v[82:85], v[14:17], v[98:101], v[82:85]
v_mfma_f32_16x16x32_bf16 v[86:89], v[18:21], v[94:97], v[42:45]
v_mfma_f32_16x16x32_bf16 v[86:89], v[22:25], v[98:101], v[86:89]
v_mfma_f32_16x16x32_bf16 v[90:93], v[26:29], v[94:97], v[46:49]
v_mfma_f32_16x16x32_bf16 v[90:93], v[30:33], v[98:101], v[90:93]
v_mul_f32 v114, v114, v110
v_mul_f32 v115, v115, v111
v_mul_f32 v116, v116, v112
v_mul_f32 v117, v117, v113
v_cvt_pk_bf16_f32 v114, v114, v115
v_cvt_pk_bf16_f32 v115, v116, v117
v_exp_f32 v78, v78
v_exp_f32 v79, v79
v_exp_f32 v80, v80
v_exp_f32 v81, v81
v_mfma_f32_4x4x4_16b_bf16 v[50:53], v[114:115], v[102:103], v[50:53]
v_exp_f32 v82, v82
v_exp_f32 v83, v83
v_exp_f32 v84, v84
v_exp_f32 v85, v85
v_mfma_f32_4x4x4_16b_bf16 v[54:57], v[114:115], v[104:105], v[54:57]
v_exp_f32 v86, v86
v_exp_f32 v87, v87
v_exp_f32 v88, v88
v_exp_f32 v89, v89
v_mfma_f32_4x4x4_16b_bf16 v[58:61], v[114:115], v[106:107], v[58:61]
v_exp_f32 v90, v90
v_exp_f32 v91, v91
v_exp_f32 v92, v92
v_exp_f32 v93, v93
v_mfma_f32_4x4x4_16b_bf16 v[62:65], v[114:115], v[108:109], v[62:65]
ds_read_b64_tr_b16 v[102:103], v120 offset:0
ds_read_b64_tr_b16 v[104:105], v121 offset:0
ds_read_b64_tr_b16 v[106:107], v122 offset:0
ds_read_b64_tr_b16 v[108:109], v123 offset:0
ds_read_b128 v[110:113], v125 offset:5376
v_cvt_pk_f16_f32 v78, v78, v79
v_cvt_pk_f16_f32 v79, v80, v81
v_cvt_pk_f16_f32 v80, v82, v83
v_cvt_pk_f16_f32 v81, v84, v85
v_cvt_pk_f16_f32 v82, v86, v87
v_cvt_pk_f16_f32 v83, v88, v89
v_cvt_pk_f16_f32 v84, v90, v91
v_cvt_pk_f16_f32 v85, v92, v93
v_pk_add_f16 v78, v78, s69
v_pk_add_f16 v79, v79, s69
v_pk_add_f16 v80, v80, s69
v_pk_add_f16 v81, v81, s69
v_pk_add_f16 v82, v82, s69
v_pk_add_f16 v83, v83, s69
v_pk_add_f16 v84, v84, s69
v_pk_add_f16 v85, v85, s69
v_rcp_f16_sdwa v78, v78 dst_sel:WORD_0 dst_unused:UNUSED_PRESERVE src0_sel:WORD_0
v_rcp_f16_sdwa v79, v79 dst_sel:WORD_0 dst_unused:UNUSED_PRESERVE src0_sel:WORD_0
v_rcp_f16_sdwa v80, v80 dst_sel:WORD_0 dst_unused:UNUSED_PRESERVE src0_sel:WORD_0
v_rcp_f16_sdwa v81, v81 dst_sel:WORD_0 dst_unused:UNUSED_PRESERVE src0_sel:WORD_0
v_rcp_f16_sdwa v82, v82 dst_sel:WORD_0 dst_unused:UNUSED_PRESERVE src0_sel:WORD_0
v_rcp_f16_sdwa v83, v83 dst_sel:WORD_0 dst_unused:UNUSED_PRESERVE src0_sel:WORD_0
v_rcp_f16_sdwa v84, v84 dst_sel:WORD_0 dst_unused:UNUSED_PRESERVE src0_sel:WORD_0
v_rcp_f16_sdwa v85, v85 dst_sel:WORD_0 dst_unused:UNUSED_PRESERVE src0_sel:WORD_0
v_rcp_f16_sdwa v78, v78 dst_sel:WORD_1 dst_unused:UNUSED_PRESERVE src0_sel:WORD_1
v_rcp_f16_sdwa v79, v79 dst_sel:WORD_1 dst_unused:UNUSED_PRESERVE src0_sel:WORD_1
v_rcp_f16_sdwa v80, v80 dst_sel:WORD_1 dst_unused:UNUSED_PRESERVE src0_sel:WORD_1
v_rcp_f16_sdwa v81, v81 dst_sel:WORD_1 dst_unused:UNUSED_PRESERVE src0_sel:WORD_1
v_rcp_f16_sdwa v82, v82 dst_sel:WORD_1 dst_unused:UNUSED_PRESERVE src0_sel:WORD_1
v_rcp_f16_sdwa v83, v83 dst_sel:WORD_1 dst_unused:UNUSED_PRESERVE src0_sel:WORD_1
v_rcp_f16_sdwa v84, v84 dst_sel:WORD_1 dst_unused:UNUSED_PRESERVE src0_sel:WORD_1
v_rcp_f16_sdwa v85, v85 dst_sel:WORD_1 dst_unused:UNUSED_PRESERVE src0_sel:WORD_1
s_waitcnt lgkmcnt(0)
s_nop 0
v_mfma_f32_16x16x32_f16 v[114:117], v[78:81], v[66:69], v[74:77]
v_mfma_f32_16x16x32_f16 v[114:117], v[82:85], v[70:73], v[114:117]
L_drain_g:
s_waitcnt lgkmcnt(0)
s_nop 6
v_mul_f32 v114, v114, v110
v_mul_f32 v115, v115, v111
v_mul_f32 v116, v116, v112
v_mul_f32 v117, v117, v113
v_cvt_pk_bf16_f32 v114, v114, v115
v_cvt_pk_bf16_f32 v115, v116, v117
s_nop 1
v_mfma_f32_4x4x4_16b_bf16 v[50:53], v[114:115], v[102:103], v[50:53]
v_mfma_f32_4x4x4_16b_bf16 v[54:57], v[114:115], v[104:105], v[54:57]
v_mfma_f32_4x4x4_16b_bf16 v[58:61], v[114:115], v[106:107], v[58:61]
v_mfma_f32_4x4x4_16b_bf16 v[62:65], v[114:115], v[108:109], v[62:65]
s_branch L_end
L_drain0_g:
s_waitcnt lgkmcnt(0)
s_nop 6
v_mul_f32 v114, v114, v110
v_mul_f32 v115, v115, v111
v_mul_f32 v116, v116, v112
v_mul_f32 v117, v117, v113
v_cvt_pk_bf16_f32 v114, v114, v115
v_cvt_pk_bf16_f32 v115, v116, v117
s_nop 1
v_mfma_f32_4x4x4_16b_bf16 v[50:53], v[114:115], v[102:103], 0
v_mfma_f32_4x4x4_16b_bf16 v[54:57], v[114:115], v[104:105], 0
v_mfma_f32_4x4x4_16b_bf16 v[58:61], v[114:115], v[106:107], 0
v_mfma_f32_4x4x4_16b_bf16 v[62:65], v[114:115], v[108:109], 0
s_branch L_end
L_empty:
v_mov_b32 v50, 0
v_lshlrev_b32 v127, 1, v0
s_branch L_store
L_done:
s_endpgm
.section .rodata,"a"
.p2align 6
.amdhsa_kernel standalone__sequential_behavior_din__recsys_kernel
  .amdhsa_next_free_vgpr 128
  .amdhsa_next_free_sgpr 72
  .amdhsa_accum_offset 128
  .amdhsa_group_segment_fixed_size 0
  .amdhsa_kernarg_size 80
  .amdhsa_user_sgpr_count 2
  .amdhsa_user_sgpr_kernarg_segment_ptr 1
  .amdhsa_system_sgpr_workgroup_id_x 1
  .amdhsa_float_denorm_mode_32 3
.end_amdhsa_kernel
```
